```python
import torch

def _softmax(x, axis=-1):
    return torch.softmax(x, dim=axis)
def _gelu(x):
    return torch.nn.functional.gelu(x, approximate="tanh")
def _silu(x):
    return torch.nn.functional.silu(x)
def _sigmoid(x):
    return torch.sigmoid(x)
def _layernorm(x, axis=-1, eps=1e-5):
    m = x.mean(dim=axis, keepdim=True)
    v = x.var(dim=axis, keepdim=True, unbiased=False)
    return (x - m) / torch.sqrt(v + eps)
def _scatter_add(tgt, idx, src, axis=0):
    return tgt.clone().index_add_(axis, idx, src)
def _segment_sum(src, seg, n):
    out = torch.zeros((n,) + src.shape[1:], dtype=src.dtype)
    return out.index_add_(0, seg, src)
def _pad(x, pw):
    flat = tuple(v for pair in reversed(pw) for v in pair)
    return torch.nn.functional.pad(x, flat)

kernel_name = 'gated_mix__sliding_block_cached__sliding_block_cached__decode'

def setup_inputs():

    _w = (lambda a: (lambda t: t.to(torch.bfloat16) if t.is_floating_point() else t)(torch.as_tensor(a)))
    def _A_setup():
        B, Sq, D = 8, 1, 512
        Hq, Hkv, Sk, Dh = 32, 8, 8192, 128
        assert Hq % Hkv == 0, (Hq, Hkv)
        return {
            "x": _w((lambda *s: torch.randn(*s, dtype=torch.bfloat16) * 0.05)(B, Sq, D)),
            "k_cache": _w((lambda *s: torch.randn(*s, dtype=torch.bfloat16) * 6.4)(B, Hkv, Sk, Dh)),
            "v_cache": _w((lambda *s: torch.randn(*s, dtype=torch.bfloat16) * 0.05)(B, Hkv, Sk, Dh)),
            "wq": _w((lambda *s: torch.randn(*s, dtype=torch.bfloat16) * 6.4)(D, Hq * Dh) * (D ** -0.5)),
            "wo": _w((lambda *s: torch.randn(*s, dtype=torch.bfloat16) * 0.05)(Hq * Dh, D) * ((Hq * Dh) ** -0.5)),
        }
    _A_in = _A_setup()

    def _B_setup():
        B, Sq, D = 8, 1, 512
        Hq, Hkv, Sk, Dh = 32, 8, 8192, 128
        assert Hq % Hkv == 0, (Hq, Hkv)
        return {
            "x": _w((lambda *s: torch.randn(*s, dtype=torch.bfloat16) * 0.05)(B, Sq, D)),
            "k_cache": _w((lambda *s: torch.randn(*s, dtype=torch.bfloat16) * 6.4)(B, Hkv, Sk, Dh)),
            "v_cache": _w((lambda *s: torch.randn(*s, dtype=torch.bfloat16) * 0.05)(B, Hkv, Sk, Dh)),
            "wq": _w((lambda *s: torch.randn(*s, dtype=torch.bfloat16) * 6.4)(D, Hq * Dh) * (D ** -0.5)),
            "wo": _w((lambda *s: torch.randn(*s, dtype=torch.bfloat16) * 0.05)(Hq * Dh, D) * ((Hq * Dh) ** -0.5)),
        }
    _B_in = _B_setup()

    return {
        "A_x": _A_in["x"],
        "A_k_cache": _A_in["k_cache"],
        "A_v_cache": _A_in["v_cache"],
        "A_wq": _A_in["wq"],
        "A_wo": _A_in["wo"],
        "B_x": _B_in["x"],
        "B_k_cache": _B_in["k_cache"],
        "B_v_cache": _B_in["v_cache"],
        "B_wq": _B_in["wq"],
        "B_wo": _B_in["wo"],
        "gate_w": _w((lambda *s: torch.randn(*s, dtype=torch.bfloat16) * 0.05)(512) * 16.0),
    }

def reference(A_x, A_k_cache, A_v_cache, A_wq, A_wo, B_x, B_k_cache, B_v_cache, B_wq, B_wo, gate_w):
    def _A_ref(x, k_cache, v_cache, wq, wo):
        B, Sq, D = x.shape
        Hq, Dh = 32, 128
        Hkv, Sk = k_cache.shape[1], k_cache.shape[2]
        W = min(4096, max(256, Sk // 4))
        rep = Hq // Hkv
        q = (lambda x, *d: x.permute(*d))((x @ wq).reshape(B, Sq, Hq, Dh), 0, 2, 1, 3)
        k = (lambda x, n, axis: torch.repeat_interleave(x, n, dim=axis))(k_cache[:, :, Sk - W:, :], rep, axis=1)
        v = (lambda x, n, axis: torch.repeat_interleave(x, n, dim=axis))(v_cache[:, :, Sk - W:, :], rep, axis=1)
        scores = torch.einsum("bhqd,bhkd->bhqk", q, k) * (Dh ** -0.5)
        p = _softmax(scores, axis=-1)
        o = torch.einsum("bhqk,bhkd->bhqd", p, v)
        return (lambda x, *d: x.permute(*d))(o, 0, 2, 1, 3).reshape(B, Sq, Hq * Dh) @ wo

    def _B_ref(x, k_cache, v_cache, wq, wo):
        B, Sq, D = x.shape
        Hq, Dh = 32, 128
        Hkv, Sk = k_cache.shape[1], k_cache.shape[2]
        W = min(4096, max(256, Sk // 4))
        rep = Hq // Hkv
        q = (lambda x, *d: x.permute(*d))((x @ wq).reshape(B, Sq, Hq, Dh), 0, 2, 1, 3)
        k = (lambda x, n, axis: torch.repeat_interleave(x, n, dim=axis))(k_cache[:, :, Sk - W:, :], rep, axis=1)
        v = (lambda x, n, axis: torch.repeat_interleave(x, n, dim=axis))(v_cache[:, :, Sk - W:, :], rep, axis=1)
        scores = torch.einsum("bhqd,bhkd->bhqk", q, k) * (Dh ** -0.5)
        p = _softmax(scores, axis=-1)
        o = torch.einsum("bhqk,bhkd->bhqd", p, v)
        return (lambda x, *d: x.permute(*d))(o, 0, 2, 1, 3).reshape(B, Sq, Hq * Dh) @ wo

    x = A_x
    g = _sigmoid((x * gate_w).sum(-1, keepdims=True))
    a = _A_ref(x, A_k_cache, A_v_cache, A_wq, A_wo)
    b = _B_ref(x, B_k_cache, B_v_cache, B_wq, B_wo)
    return g * a + (1 - g) * b
```

```asm
; @launch grid=(256,1,1) block=(384,1,1) lds=163840
.amdgcn_target "amdgcn-amd-amdhsa--gfx950"
.text
.globl gated_mix__sliding_block_cached__sliding_block_cached__decode_kernel
.p2align 8
.type gated_mix__sliding_block_cached__sliding_block_cached__decode_kernel,@function
gated_mix__sliding_block_cached__sliding_block_cached__decode_kernel:
    s_cmp_ge_u32 s2, 256
    s_cbranch_scc1 L_end
    s_load_dwordx8 s[8:15], s[0:1], 8
    s_load_dwordx8 s[16:23], s[0:1], 48
    s_load_dwordx8 s[24:31], s[0:1], 80
    s_load_dwordx2 s[32:33], s[0:1], 0
    v_lshrrev_b32 v1, 6, v0
    v_and_b32 v0, 63, v0
    s_lshr_b32 s34, s2, 7
    v_readfirstlane_b32 s3, v1
    s_and_b32 s35, s2, 7
    s_lshr_b32 s36, s2, 3
    s_and_b32 s36, s36, 15
    s_lshl_b32 s37, s34, 3
    s_add_u32 s37, s37, s35
    s_and_b32 s66, s36, 7
    s_and_b32 s36, s36, 8
    s_or_b32 s36, s36, s35
    s_mov_b32 s35, s66
    s_lshl_b32 s37, s34, 3
    s_add_u32 s37, s37, s35
    s_lshr_b32 s38, s36, 1
    s_and_b32 s39, s36, 1
    s_lshr_b32 s40, s36, 2
    s_and_b32 s41, s36, 3
    s_mov_b32 s64, 0x3e0293ee
    s_mov_b32 s65, 0xbe0293ee
    s_cmp_lt_u32 s3, 4
    s_cbranch_scc1 L_stream
    s_cmp_eq_u32 s3, 5
    s_cbranch_scc1 L_wwave
L_qwave:
    s_setprio 3
    v_and_b32 v12, 7, v0
    v_lshlrev_b32 v12, 10, v12
    v_lshrrev_b32 v13, 4, v0
    v_lshlrev_b32 v13, 3, v13
    v_add_u32 v11, v12, v13
    s_lshl_b32 s66, s41, 8
    v_add_u32 v11, s66, v11
    s_lshl_b32 s66, s41, 20
    s_lshl_b32 s67, s35, 2
    s_add_u32 s67, s67, s40
    s_lshl_b32 s67, s67, 8
    s_add_u32 s66, s66, s67
    v_lshrrev_b32 v12, 4, v0
    v_and_b32 v13, 15, v0
    v_lshlrev_b32 v1, 1, v12
    v_xor_b32 v1, v1, v13
    v_lshlrev_b32 v1, 4, v1
    v_lshlrev_b32 v2, 1, v12
    v_add_u32 v2, 8, v2
    v_xor_b32 v2, v2, v13
    v_lshlrev_b32 v2, 4, v2
    v_mul_u32_u24 v12, 8192, v12
    v_add_u32 v1, v1, v12
    v_add_u32 v2, v2, v12
    s_waitcnt lgkmcnt(0)
    s_cmp_lg_u32 s34, 0
    s_cselect_b64 s[8:9], s[16:17], s[8:9]
    s_cselect_b64 s[10:11], s[18:19], s[10:11]
    s_cselect_b64 s[12:13], s[20:21], s[12:13]
    s_cselect_b64 s[14:15], s[22:23], s[14:15]
    s_mov_b32 s52, s30
    s_mov_b32 s53, s31
    s_mov_b32 s54, 8388608
    s_mov_b32 s55, 0x00020000
    s_mov_b32 s5, 0xffffff00
    s_mov_b32 s48, s32
    s_mov_b32 s49, s33
    s_mov_b32 s50, 8192
    s_mov_b32 s51, 0x00020000
    s_add_u32 s44, s12, s66
    s_addc_u32 s45, s13, 0
    s_mov_b32 s46, 1040640
    s_mov_b32 s47, 0x00020000
    buffer_load_dwordx2 v[20:21], v11, s[48:51], 0 offen offset:0
    buffer_load_dwordx2 v[22:23], v11, s[48:51], 0 offen offset:32
    buffer_load_dwordx2 v[24:25], v11, s[48:51], 0 offen offset:64
    buffer_load_dwordx2 v[26:27], v11, s[48:51], 0 offen offset:96
    buffer_load_dwordx2 v[28:29], v11, s[48:51], 0 offen offset:128
    buffer_load_dwordx2 v[30:31], v11, s[48:51], 0 offen offset:160
    buffer_load_dwordx2 v[32:33], v11, s[48:51], 0 offen offset:192
    buffer_load_dwordx2 v[34:35], v11, s[48:51], 0 offen offset:224
    s_mov_b32 m0, 98304
    s_mov_b32 s74, 0
    buffer_load_dwordx4 v1, s[44:47], s74 offen offset:0 nt lds
    s_mov_b32 s75, 31744
    buffer_load_dwordx4 v2, s[44:47], s75 offen offset:1024 nt lds
    s_mov_b32 s76, 63488
    buffer_load_dwordx4 v1, s[44:47], s76 offen offset:2048 nt lds
    s_mov_b32 s77, 95232
    buffer_load_dwordx4 v2, s[44:47], s77 offen offset:3072 nt lds
    s_mov_b32 m0, 102400
    s_mov_b32 s74, 131072
    buffer_load_dwordx4 v1, s[44:47], s74 offen offset:0 nt lds
    s_mov_b32 s75, 162816
    buffer_load_dwordx4 v2, s[44:47], s75 offen offset:1024 nt lds
    s_mov_b32 s76, 194560
    buffer_load_dwordx4 v1, s[44:47], s76 offen offset:2048 nt lds
    s_mov_b32 s77, 226304
    buffer_load_dwordx4 v2, s[44:47], s77 offen offset:3072 nt lds
    s_mov_b32 m0, 106496
    s_mov_b32 s74, 262144
    buffer_load_dwordx4 v1, s[44:47], s74 offen offset:0 nt lds
    s_mov_b32 s75, 293888
    buffer_load_dwordx4 v2, s[44:47], s75 offen offset:1024 nt lds
    s_mov_b32 s76, 325632
    buffer_load_dwordx4 v1, s[44:47], s76 offen offset:2048 nt lds
    s_mov_b32 s77, 357376
    buffer_load_dwordx4 v2, s[44:47], s77 offen offset:3072 nt lds
    s_mov_b32 m0, 110592
    s_mov_b32 s74, 393216
    buffer_load_dwordx4 v1, s[44:47], s74 offen offset:0 nt lds
    s_mov_b32 s75, 424960
    buffer_load_dwordx4 v2, s[44:47], s75 offen offset:1024 nt lds
    s_mov_b32 s76, 456704
    buffer_load_dwordx4 v1, s[44:47], s76 offen offset:2048 nt lds
    s_mov_b32 s77, 488448
    buffer_load_dwordx4 v2, s[44:47], s77 offen offset:3072 nt lds
    s_mov_b32 m0, 114688
    s_mov_b32 s74, 524288
    buffer_load_dwordx4 v1, s[44:47], s74 offen offset:0 nt lds
    s_mov_b32 s75, 556032
    buffer_load_dwordx4 v2, s[44:47], s75 offen offset:1024 nt lds
    s_mov_b32 s76, 587776
    buffer_load_dwordx4 v1, s[44:47], s76 offen offset:2048 nt lds
    s_mov_b32 s77, 619520
    buffer_load_dwordx4 v2, s[44:47], s77 offen offset:3072 nt lds
    s_mov_b32 m0, 118784
    s_mov_b32 s74, 655360
    buffer_load_dwordx4 v1, s[44:47], s74 offen offset:0 nt lds
    s_mov_b32 s75, 687104
    buffer_load_dwordx4 v2, s[44:47], s75 offen offset:1024 nt lds
    s_mov_b32 s76, 718848
    buffer_load_dwordx4 v1, s[44:47], s76 offen offset:2048 nt lds
    s_mov_b32 s77, 750592
    buffer_load_dwordx4 v2, s[44:47], s77 offen offset:3072 nt lds
    s_mov_b32 m0, 122880
    s_mov_b32 s74, 786432
    buffer_load_dwordx4 v1, s[44:47], s74 offen offset:0 nt lds
    s_mov_b32 s75, 818176
    buffer_load_dwordx4 v2, s[44:47], s75 offen offset:1024 nt lds
    s_mov_b32 s76, 849920
    buffer_load_dwordx4 v1, s[44:47], s76 offen offset:2048 nt lds
    s_mov_b32 s77, 881664
    buffer_load_dwordx4 v2, s[44:47], s77 offen offset:3072 nt lds
    s_mov_b32 m0, 126976
    s_mov_b32 s74, 917504
    buffer_load_dwordx4 v1, s[44:47], s74 offen offset:0 nt lds
    s_mov_b32 s75, 949248
    buffer_load_dwordx4 v2, s[44:47], s75 offen offset:1024 nt lds
    s_mov_b32 s76, 980992
    buffer_load_dwordx4 v1, s[44:47], s76 offen offset:2048 nt lds
    s_mov_b32 s77, 1012736
    buffer_load_dwordx4 v2, s[44:47], s77 offen offset:3072 nt lds
    s_load_dword s4, s[30:31], 0
    s_barrier
    v_lshrrev_b32 v13, 2, v0
    v_and_b32 v14, 7, v13
    v_lshlrev_b32 v14, 5, v14
    v_lshlrev_b32 v13, 8, v13
    v_add_u32 v13, v13, v14
    v_and_b32 v14, 3, v0
    v_lshlrev_b32 v14, 3, v14
    v_add_u32 v13, v13, v14
    v_xor_b32 v3, 0, v13
    v_xor_b32 v4, 32, v13
    v_xor_b32 v5, 64, v13
    v_xor_b32 v6, 96, v13
    v_xor_b32 v7, 128, v13
    v_xor_b32 v8, 160, v13
    v_xor_b32 v9, 192, v13
    v_xor_b32 v10, 224, v13
    v_add_u32 v3, 98304, v3
    v_add_u32 v4, 98304, v4
    v_add_u32 v5, 98304, v5
    v_add_u32 v6, 98304, v6
    v_add_u32 v7, 98304, v7
    v_add_u32 v8, 98304, v8
    v_add_u32 v9, 98304, v9
    v_add_u32 v10, 98304, v10
    s_lshl_b32 s66, s37, 4
    s_add_u32 s66, s66, s36
    s_lshl_b32 s69, s66, 12
    v_and_b32 v12, 7, v0
    v_lshlrev_b32 v12, 9, v12
    v_lshrrev_b32 v13, 4, v0
    v_lshlrev_b32 v13, 4, v13
    v_add_u32 v12, v12, v13
    s_add_u32 s69, s69, 3145728
    v_add_u32 v14, s69, v12
    v_lshrrev_b32 v12, 5, v0
    v_lshlrev_b32 v12, 14, v12
    v_and_b32 v13, 31, v0
    v_lshlrev_b32 v13, 4, v13
    v_add_u32 v12, v12, v13
    s_lshl_b32 s66, s37, 16
    s_lshl_b32 s67, s38, 9
    s_add_u32 s66, s66, s67
    v_add_u32 v15, s66, v12
    s_mov_b32 s74, 3145728
    s_mov_b32 s75, 3149824
    s_mov_b32 s76, 3153920
    s_mov_b32 s77, 3158016
    s_mov_b32 s78, 3178496
    s_mov_b32 s79, 3182592
    s_mov_b32 s80, 3186688
    s_mov_b32 s81, 3190784
    s_waitcnt lgkmcnt(0)
    s_add_u32 s16, s4, 1
    s_and_b32 s16, s16, 0xff
    s_add_u32 s17, s4, 65
    s_and_b32 s17, s17, 0xff
    s_add_u32 s18, s4, 129
    s_and_b32 s18, s18, 0xff
    s_add_u32 s19, s4, 193
    s_and_b32 s19, s19, 0xff
    v_mov_b32 v16, s16
    v_mov_b32 v17, s17
    v_mov_b32 v18, s18
    v_mov_b32 v19, s19
    s_waitcnt vmcnt(24)
    ds_read_b64_tr_b16 v[128:129], v3 offset:0
    ds_read_b64_tr_b16 v[130:131], v3 offset:4096
    ds_read_b64_tr_b16 v[132:133], v4 offset:0
    ds_read_b64_tr_b16 v[134:135], v4 offset:4096
    ds_read_b64_tr_b16 v[136:137], v5 offset:0
    ds_read_b64_tr_b16 v[138:139], v5 offset:4096
    ds_read_b64_tr_b16 v[140:141], v6 offset:0
    ds_read_b64_tr_b16 v[142:143], v6 offset:4096
    ds_read_b64_tr_b16 v[144:145], v7 offset:0
    ds_read_b64_tr_b16 v[146:147], v7 offset:4096
    ds_read_b64_tr_b16 v[148:149], v8 offset:0
    ds_read_b64_tr_b16 v[150:151], v8 offset:4096
    ds_read_b64_tr_b16 v[152:153], v9 offset:0
    ds_read_b64_tr_b16 v[154:155], v9 offset:4096
    ds_read_b64_tr_b16 v[156:157], v10 offset:0
    ds_read_b64_tr_b16 v[158:159], v10 offset:4096
    s_waitcnt vmcnt(16)
    ds_read_b64_tr_b16 v[160:161], v3 offset:8192
    ds_read_b64_tr_b16 v[162:163], v3 offset:12288
    ds_read_b64_tr_b16 v[164:165], v4 offset:8192
    ds_read_b64_tr_b16 v[166:167], v4 offset:12288
    ds_read_b64_tr_b16 v[168:169], v5 offset:8192
    ds_read_b64_tr_b16 v[170:171], v5 offset:12288
    ds_read_b64_tr_b16 v[172:173], v6 offset:8192
    ds_read_b64_tr_b16 v[174:175], v6 offset:12288
    ds_read_b64_tr_b16 v[176:177], v7 offset:8192
    ds_read_b64_tr_b16 v[178:179], v7 offset:12288
    ds_read_b64_tr_b16 v[180:181], v8 offset:8192
    ds_read_b64_tr_b16 v[182:183], v8 offset:12288
    ds_read_b64_tr_b16 v[184:185], v9 offset:8192
    ds_read_b64_tr_b16 v[186:187], v9 offset:12288
    ds_read_b64_tr_b16 v[188:189], v10 offset:8192
    ds_read_b64_tr_b16 v[190:191], v10 offset:12288
    s_waitcnt lgkmcnt(15)
    v_mfma_f32_16x16x32_bf16 v[68:71], v[128:131], v[20:23], 0
    v_mfma_f32_16x16x32_bf16 v[72:75], v[132:135], v[20:23], 0
    v_mfma_f32_16x16x32_bf16 v[76:79], v[136:139], v[20:23], 0
    v_mfma_f32_16x16x32_bf16 v[80:83], v[140:143], v[20:23], 0
    v_mfma_f32_16x16x32_bf16 v[84:87], v[144:147], v[20:23], 0
    v_mfma_f32_16x16x32_bf16 v[88:91], v[148:151], v[20:23], 0
    v_mfma_f32_16x16x32_bf16 v[92:95], v[152:155], v[20:23], 0
    v_mfma_f32_16x16x32_bf16 v[96:99], v[156:159], v[20:23], 0
    s_waitcnt vmcnt(8)
    ds_read_b64_tr_b16 v[192:193], v3 offset:16384
    ds_read_b64_tr_b16 v[194:195], v3 offset:20480
    ds_read_b64_tr_b16 v[196:197], v4 offset:16384
    ds_read_b64_tr_b16 v[198:199], v4 offset:20480
    ds_read_b64_tr_b16 v[200:201], v5 offset:16384
    ds_read_b64_tr_b16 v[202:203], v5 offset:20480
    ds_read_b64_tr_b16 v[204:205], v6 offset:16384
    ds_read_b64_tr_b16 v[206:207], v6 offset:20480
    ds_read_b64_tr_b16 v[208:209], v7 offset:16384
    ds_read_b64_tr_b16 v[210:211], v7 offset:20480
    ds_read_b64_tr_b16 v[212:213], v8 offset:16384
    ds_read_b64_tr_b16 v[214:215], v8 offset:20480
    ds_read_b64_tr_b16 v[216:217], v9 offset:16384
    ds_read_b64_tr_b16 v[218:219], v9 offset:20480
    ds_read_b64_tr_b16 v[220:221], v10 offset:16384
    ds_read_b64_tr_b16 v[222:223], v10 offset:20480
    s_waitcnt lgkmcnt(15)
    v_mfma_f32_16x16x32_bf16 v[68:71], v[160:163], v[24:27], v[68:71]
    v_mfma_f32_16x16x32_bf16 v[72:75], v[164:167], v[24:27], v[72:75]
    v_mfma_f32_16x16x32_bf16 v[76:79], v[168:171], v[24:27], v[76:79]
    v_mfma_f32_16x16x32_bf16 v[80:83], v[172:175], v[24:27], v[80:83]
    v_mfma_f32_16x16x32_bf16 v[84:87], v[176:179], v[24:27], v[84:87]
    v_mfma_f32_16x16x32_bf16 v[88:91], v[180:183], v[24:27], v[88:91]
    v_mfma_f32_16x16x32_bf16 v[92:95], v[184:187], v[24:27], v[92:95]
    v_mfma_f32_16x16x32_bf16 v[96:99], v[188:191], v[24:27], v[96:99]
    s_waitcnt vmcnt(0)
    ds_read_b64_tr_b16 v[224:225], v3 offset:24576
    ds_read_b64_tr_b16 v[226:227], v3 offset:28672
    ds_read_b64_tr_b16 v[228:229], v4 offset:24576
    ds_read_b64_tr_b16 v[230:231], v4 offset:28672
    ds_read_b64_tr_b16 v[232:233], v5 offset:24576
    ds_read_b64_tr_b16 v[234:235], v5 offset:28672
    ds_read_b64_tr_b16 v[236:237], v6 offset:24576
    ds_read_b64_tr_b16 v[238:239], v6 offset:28672
    ds_read_b64_tr_b16 v[240:241], v7 offset:24576
    ds_read_b64_tr_b16 v[242:243], v7 offset:28672
    ds_read_b64_tr_b16 v[244:245], v8 offset:24576
    ds_read_b64_tr_b16 v[246:247], v8 offset:28672
    ds_read_b64_tr_b16 v[248:249], v9 offset:24576
    ds_read_b64_tr_b16 v[250:251], v9 offset:28672
    ds_read_b64_tr_b16 v[252:253], v10 offset:24576
    ds_read_b64_tr_b16 v[254:255], v10 offset:28672
    s_waitcnt lgkmcnt(15)
    v_mfma_f32_16x16x32_bf16 v[68:71], v[192:195], v[28:31], v[68:71]
    v_mfma_f32_16x16x32_bf16 v[72:75], v[196:199], v[28:31], v[72:75]
    v_mfma_f32_16x16x32_bf16 v[76:79], v[200:203], v[28:31], v[76:79]
    v_mfma_f32_16x16x32_bf16 v[80:83], v[204:207], v[28:31], v[80:83]
    v_mfma_f32_16x16x32_bf16 v[84:87], v[208:211], v[28:31], v[84:87]
    v_mfma_f32_16x16x32_bf16 v[88:91], v[212:215], v[28:31], v[88:91]
    v_mfma_f32_16x16x32_bf16 v[92:95], v[216:219], v[28:31], v[92:95]
    v_mfma_f32_16x16x32_bf16 v[96:99], v[220:223], v[28:31], v[96:99]
    s_waitcnt lgkmcnt(0)
    v_mfma_f32_16x16x32_bf16 v[68:71], v[224:227], v[32:35], v[68:71]
    v_mfma_f32_16x16x32_bf16 v[72:75], v[228:231], v[32:35], v[72:75]
    v_mfma_f32_16x16x32_bf16 v[76:79], v[232:235], v[32:35], v[76:79]
    v_mfma_f32_16x16x32_bf16 v[80:83], v[236:239], v[32:35], v[80:83]
    v_mfma_f32_16x16x32_bf16 v[84:87], v[240:243], v[32:35], v[84:87]
    v_mfma_f32_16x16x32_bf16 v[88:91], v[244:247], v[32:35], v[88:91]
    v_mfma_f32_16x16x32_bf16 v[92:95], v[248:251], v[32:35], v[92:95]
    v_mfma_f32_16x16x32_bf16 v[96:99], v[252:255], v[32:35], v[96:99]
    s_mov_b32 s72, 0x00ff00ff
    s_mov_b32 s73, 0x00ff00ff
    s_nop 5
    v_and_or_b32 v68, v68, s5, v16
    v_and_or_b32 v69, v69, s5, v17
    v_and_or_b32 v70, v70, s5, v18
    v_and_or_b32 v71, v71, s5, v19
    v_and_or_b32 v72, v72, s5, v16
    v_and_or_b32 v73, v73, s5, v17
    v_and_or_b32 v74, v74, s5, v18
    v_and_or_b32 v75, v75, s5, v19
    v_and_or_b32 v76, v76, s5, v16
    v_and_or_b32 v77, v77, s5, v17
    v_and_or_b32 v78, v78, s5, v18
    v_and_or_b32 v79, v79, s5, v19
    v_and_or_b32 v80, v80, s5, v16
    v_and_or_b32 v81, v81, s5, v17
    v_and_or_b32 v82, v82, s5, v18
    v_and_or_b32 v83, v83, s5, v19
    v_and_or_b32 v84, v84, s5, v16
    v_and_or_b32 v85, v85, s5, v17
    v_and_or_b32 v86, v86, s5, v18
    v_and_or_b32 v87, v87, s5, v19
    v_and_or_b32 v88, v88, s5, v16
    v_and_or_b32 v89, v89, s5, v17
    v_and_or_b32 v90, v90, s5, v18
    v_and_or_b32 v91, v91, s5, v19
    v_and_or_b32 v92, v92, s5, v16
    v_and_or_b32 v93, v93, s5, v17
    v_and_or_b32 v94, v94, s5, v18
    v_and_or_b32 v95, v95, s5, v19
    s_nop 1
    v_and_or_b32 v96, v96, s5, v16
    v_and_or_b32 v97, v97, s5, v17
    v_and_or_b32 v98, v98, s5, v18
    v_and_or_b32 v99, v99, s5, v19
    s_mov_b64 exec, s[72:73]
    buffer_store_dwordx4 v[68:71], v14, s[52:55], 0 offen offset:0 sc1
    buffer_store_dwordx4 v[72:75], v14, s[52:55], 0 offen offset:64 sc1
    buffer_store_dwordx4 v[76:79], v14, s[52:55], 0 offen offset:128 sc1
    buffer_store_dwordx4 v[80:83], v14, s[52:55], 0 offen offset:192 sc1
    buffer_store_dwordx4 v[84:87], v14, s[52:55], 0 offen offset:256 sc1
    buffer_store_dwordx4 v[88:91], v14, s[52:55], 0 offen offset:320 sc1
    buffer_store_dwordx4 v[92:95], v14, s[52:55], 0 offen offset:384 sc1
    buffer_store_dwordx4 v[96:99], v14, s[52:55], 0 offen offset:448 sc1
    s_mov_b64 exec, -1
    s_mov_b32 s70, 200000
L_qpoll:
    buffer_load_dwordx4 v[36:39], v15, s[52:55], s74 offen sc1
    buffer_load_dwordx4 v[40:43], v15, s[52:55], s75 offen sc1
    buffer_load_dwordx4 v[44:47], v15, s[52:55], s76 offen sc1
    buffer_load_dwordx4 v[48:51], v15, s[52:55], s77 offen sc1
    buffer_load_dwordx4 v[52:55], v15, s[52:55], s78 offen sc1
    buffer_load_dwordx4 v[56:59], v15, s[52:55], s79 offen sc1
    buffer_load_dwordx4 v[60:63], v15, s[52:55], s80 offen sc1
    buffer_load_dwordx4 v[64:67], v15, s[52:55], s81 offen sc1
    s_waitcnt vmcnt(0)
    v_xor_b32 v12, s16, v36
    v_bitop3_b32 v12, v12, v37, s17 bitop3:0xf6
    v_bitop3_b32 v12, v12, v38, s18 bitop3:0xf6
    v_bitop3_b32 v12, v12, v39, s19 bitop3:0xf6
    v_bitop3_b32 v12, v12, v40, s16 bitop3:0xf6
    v_bitop3_b32 v12, v12, v41, s17 bitop3:0xf6
    v_bitop3_b32 v12, v12, v42, s18 bitop3:0xf6
    v_bitop3_b32 v12, v12, v43, s19 bitop3:0xf6
    v_bitop3_b32 v12, v12, v44, s16 bitop3:0xf6
    v_bitop3_b32 v12, v12, v45, s17 bitop3:0xf6
    v_bitop3_b32 v12, v12, v46, s18 bitop3:0xf6
    v_bitop3_b32 v12, v12, v47, s19 bitop3:0xf6
    v_bitop3_b32 v12, v12, v48, s16 bitop3:0xf6
    v_bitop3_b32 v12, v12, v49, s17 bitop3:0xf6
    v_bitop3_b32 v12, v12, v50, s18 bitop3:0xf6
    v_bitop3_b32 v12, v12, v51, s19 bitop3:0xf6
    v_bitop3_b32 v12, v12, v52, s16 bitop3:0xf6
    v_bitop3_b32 v12, v12, v53, s17 bitop3:0xf6
    v_bitop3_b32 v12, v12, v54, s18 bitop3:0xf6
    v_bitop3_b32 v12, v12, v55, s19 bitop3:0xf6
    v_bitop3_b32 v12, v12, v56, s16 bitop3:0xf6
    v_bitop3_b32 v12, v12, v57, s17 bitop3:0xf6
    v_bitop3_b32 v12, v12, v58, s18 bitop3:0xf6
    v_bitop3_b32 v12, v12, v59, s19 bitop3:0xf6
    v_bitop3_b32 v12, v12, v60, s16 bitop3:0xf6
    v_bitop3_b32 v12, v12, v61, s17 bitop3:0xf6
    v_bitop3_b32 v12, v12, v62, s18 bitop3:0xf6
    v_bitop3_b32 v12, v12, v63, s19 bitop3:0xf6
    v_bitop3_b32 v12, v12, v64, s16 bitop3:0xf6
    v_bitop3_b32 v12, v12, v65, s17 bitop3:0xf6
    v_bitop3_b32 v12, v12, v66, s18 bitop3:0xf6
    v_bitop3_b32 v12, v12, v67, s19 bitop3:0xf6
    v_and_b32 v12, 0xff, v12
    v_cmp_ne_u32 vcc, 0, v12
    s_cbranch_vccz L_qpoll_done
    s_mov_b64 exec, vcc
    s_sub_u32 s70, s70, 1
    s_cmp_lg_u32 s70, 0
    s_cbranch_scc1 L_qpoll
L_qpoll_done:
    s_mov_b64 exec, -1
    v_and_b32 v36, s5, v36
    v_and_b32 v37, s5, v37
    v_and_b32 v38, s5, v38
    v_and_b32 v39, s5, v39
    v_and_b32 v40, s5, v40
    v_and_b32 v41, s5, v41
    v_and_b32 v42, s5, v42
    v_and_b32 v43, s5, v43
    v_and_b32 v44, s5, v44
    v_and_b32 v45, s5, v45
    v_and_b32 v46, s5, v46
    v_and_b32 v47, s5, v47
    v_and_b32 v48, s5, v48
    v_and_b32 v49, s5, v49
    v_and_b32 v50, s5, v50
    v_and_b32 v51, s5, v51
    v_and_b32 v52, s5, v52
    v_and_b32 v53, s5, v53
    v_and_b32 v54, s5, v54
    v_and_b32 v55, s5, v55
    v_and_b32 v56, s5, v56
    v_and_b32 v57, s5, v57
    v_and_b32 v58, s5, v58
    v_and_b32 v59, s5, v59
    v_and_b32 v60, s5, v60
    v_and_b32 v61, s5, v61
    v_and_b32 v62, s5, v62
    v_and_b32 v63, s5, v63
    v_and_b32 v64, s5, v64
    v_and_b32 v65, s5, v65
    v_and_b32 v66, s5, v66
    v_and_b32 v67, s5, v67
    v_lshlrev_b32 v13, 3, v0
    v_add_u32 v13, 98304, v13
    v_add_f32 v36, v36, v40
    v_add_f32 v44, v44, v48
    v_add_f32 v37, v37, v41
    v_add_f32 v45, v45, v49
    v_add_f32 v38, v38, v42
    v_add_f32 v46, v46, v50
    v_add_f32 v39, v39, v43
    v_add_f32 v47, v47, v51
    v_add_f32 v36, v36, v44
    v_add_f32 v37, v37, v45
    v_add_f32 v38, v38, v46
    v_add_f32 v39, v39, v47
    v_cvt_pk_bf16_f32 v40, v36, v37
    v_cvt_pk_bf16_f32 v41, v38, v39
    ds_write_b64 v13, v[40:41] offset:0
    v_add_f32 v52, v52, v56
    v_add_f32 v60, v60, v64
    v_add_f32 v53, v53, v57
    v_add_f32 v61, v61, v65
    v_add_f32 v54, v54, v58
    v_add_f32 v62, v62, v66
    v_add_f32 v55, v55, v59
    v_add_f32 v63, v63, v67
    v_add_f32 v52, v52, v60
    v_add_f32 v53, v53, v61
    v_add_f32 v54, v54, v62
    v_add_f32 v55, v55, v63
    v_cvt_pk_bf16_f32 v56, v52, v53
    v_cvt_pk_bf16_f32 v57, v54, v55
    ds_write_b64 v13, v[56:57] offset:512
    s_waitcnt lgkmcnt(0)
    s_barrier
    s_setprio 0
    s_waitcnt vmcnt(0)
    s_endpgm
L_stream:
    s_cmp_lg_u32 s39, 0
    s_mov_b32 s68, 0x1b120900
    s_mov_b32 s69, 0x38312a23
    s_cselect_b32 s68, s69, s68
    s_mov_b32 s6, 0x8090909
    s_mov_b32 s69, 0x8070707
    s_cselect_b32 s6, s69, s6
    s_lshl_b32 s69, s3, 3
    s_lshr_b32 s68, s68, s69
    s_lshr_b32 s6, s6, s69
    s_and_b32 s68, s68, 0xff
    s_and_b32 s6, s6, 0xff
    s_lshl_b32 s68, s68, 13
    s_lshl_b32 s69, s6, 13
    s_lshl_b32 s66, s38, 24
    s_lshl_b32 s67, s35, 21
    s_add_u32 s66, s66, s67
    s_add_u32 s66, s66, s68
    s_add_u32 s66, s66, 1572864
    s_mul_i32 s68, s3, 24576
    v_lshrrev_b32 v174, 4, v0
    v_and_b32 v175, 15, v0
    v_lshlrev_b32 v176, 8, v174
    v_add_u32 v1, 0, v174
    v_xor_b32 v1, v1, v175
    v_lshlrev_b32 v1, 4, v1
    v_add_u32 v1, v1, v176
    v_add_u32 v2, 4, v174
    v_xor_b32 v2, v2, v175
    v_lshlrev_b32 v2, 4, v2
    v_add_u32 v2, v2, v176
    v_add_u32 v3, 8, v174
    v_xor_b32 v3, v3, v175
    v_lshlrev_b32 v3, 4, v3
    v_add_u32 v3, v3, v176
    v_add_u32 v4, 12, v174
    v_xor_b32 v4, v4, v175
    v_lshlrev_b32 v4, 4, v4
    v_add_u32 v4, v4, v176
    v_lshrrev_b32 v174, 4, v0
    v_and_b32 v175, 15, v0
    v_lshlrev_b32 v5, 1, v174
    v_xor_b32 v5, v5, v175
    v_lshlrev_b32 v5, 4, v5
    v_lshlrev_b32 v6, 1, v174
    v_add_u32 v6, 8, v6
    v_xor_b32 v6, v6, v175
    v_lshlrev_b32 v6, 4, v6
    v_mul_u32_u24 v174, 256, v174
    v_add_u32 v5, v5, v174
    v_add_u32 v6, v6, v174
    v_lshrrev_b32 v174, 4, v0
    v_and_b32 v175, 15, v0
    v_lshlrev_b32 v176, 8, v175
    v_add_u32 v176, s68, v176
    v_add_u32 v7, 0, v174
    v_xor_b32 v7, v7, v175
    v_lshlrev_b32 v7, 4, v7
    v_add_u32 v7, v7, v176
    v_add_u32 v8, 4, v174
    v_xor_b32 v8, v8, v175
    v_lshlrev_b32 v8, 4, v8
    v_add_u32 v8, v8, v176
    v_add_u32 v9, 8, v174
    v_xor_b32 v9, v9, v175
    v_lshlrev_b32 v9, 4, v9
    v_add_u32 v9, v9, v176
    v_add_u32 v10, 12, v174
    v_xor_b32 v10, v10, v175
    v_lshlrev_b32 v10, 4, v10
    v_add_u32 v10, v10, v176
    v_lshrrev_b32 v174, 2, v0
    v_and_b32 v175, 7, v174
    v_lshlrev_b32 v175, 5, v175
    v_lshlrev_b32 v174, 8, v174
    v_add_u32 v174, v174, v175
    v_and_b32 v175, 3, v0
    v_lshlrev_b32 v175, 3, v175
    v_add_u32 v174, v174, v175
    v_xor_b32 v11, 0, v174
    v_xor_b32 v12, 32, v174
    v_xor_b32 v13, 64, v174
    v_xor_b32 v14, 96, v174
    v_xor_b32 v15, 128, v174
    v_xor_b32 v16, 160, v174
    v_xor_b32 v17, 192, v174
    v_xor_b32 v18, 224, v174
    v_add_u32 v11, 0, v11
    v_add_u32 v12, 0, v12
    v_add_u32 v13, 0, v13
    v_add_u32 v14, 0, v14
    v_add_u32 v15, 0, v15
    v_add_u32 v16, 0, v16
    v_add_u32 v17, 0, v17
    v_add_u32 v18, 0, v18
    v_add_u32 v11, s68, v11
    v_add_u32 v12, s68, v12
    v_add_u32 v13, s68, v13
    v_add_u32 v14, s68, v14
    v_add_u32 v15, s68, v15
    v_add_u32 v16, s68, v16
    v_add_u32 v17, s68, v17
    v_add_u32 v18, s68, v18
    s_waitcnt lgkmcnt(0)
    s_cmp_lg_u32 s34, 0
    s_cselect_b64 s[8:9], s[16:17], s[8:9]
    s_cselect_b64 s[10:11], s[18:19], s[10:11]
    s_cselect_b64 s[12:13], s[20:21], s[12:13]
    s_cselect_b64 s[14:15], s[22:23], s[14:15]
    s_mov_b32 s52, s30
    s_mov_b32 s53, s31
    s_mov_b32 s54, 8388608
    s_mov_b32 s55, 0x00020000
    s_mov_b32 s5, 0xffffff00
    s_add_u32 s44, s8, s66
    s_addc_u32 s45, s9, 0
    s_mov_b32 s46, s69
    s_mov_b32 s47, 0x00020000
    s_add_u32 s48, s10, s66
    s_addc_u32 s49, s11, 0
    s_mov_b32 s50, s69
    s_mov_b32 s51, 0x00020000
    s_barrier
    s_cmp_eq_u32 s6, 8
    s_cbranch_scc1 L_s8
    s_cmp_eq_u32 s6, 9
    s_cbranch_scc1 L_s9
    s_add_u32 m0, s68, 0
    s_mov_b32 s74, 0
    buffer_load_dwordx4 v1, s[44:47], s74 offen offset:0 nt lds
    buffer_load_dwordx4 v2, s[44:47], s74 offen offset:1024 nt lds
    buffer_load_dwordx4 v3, s[44:47], s74 offen offset:2048 nt lds
    buffer_load_dwordx4 v4, s[44:47], s74 offen offset:3072 nt lds
    s_add_u32 m0, s68, 4096
    s_mov_b32 s74, 4096
    buffer_load_dwordx4 v1, s[44:47], s74 offen offset:0 nt lds
    buffer_load_dwordx4 v2, s[44:47], s74 offen offset:1024 nt lds
    buffer_load_dwordx4 v3, s[44:47], s74 offen offset:2048 nt lds
    buffer_load_dwordx4 v4, s[44:47], s74 offen offset:3072 nt lds
    s_add_u32 m0, s68, 8192
    s_mov_b32 s74, 8192
    buffer_load_dwordx4 v1, s[44:47], s74 offen offset:0 nt lds
    buffer_load_dwordx4 v2, s[44:47], s74 offen offset:1024 nt lds
    buffer_load_dwordx4 v3, s[44:47], s74 offen offset:2048 nt lds
    buffer_load_dwordx4 v4, s[44:47], s74 offen offset:3072 nt lds
    s_add_u32 m0, s68, 12288
    s_mov_b32 s74, 12288
    buffer_load_dwordx4 v1, s[44:47], s74 offen offset:0 nt lds
    buffer_load_dwordx4 v2, s[44:47], s74 offen offset:1024 nt lds
    buffer_load_dwordx4 v3, s[44:47], s74 offen offset:2048 nt lds
    buffer_load_dwordx4 v4, s[44:47], s74 offen offset:3072 nt lds
    s_add_u32 m0, s68, 16384
    s_mov_b32 s74, 16384
    buffer_load_dwordx4 v1, s[44:47], s74 offen offset:0 nt lds
    buffer_load_dwordx4 v2, s[44:47], s74 offen offset:1024 nt lds
    buffer_load_dwordx4 v3, s[44:47], s74 offen offset:2048 nt lds
    buffer_load_dwordx4 v4, s[44:47], s74 offen offset:3072 nt lds
    s_add_u32 m0, s68, 20480
    s_mov_b32 s74, 20480
    buffer_load_dwordx4 v1, s[44:47], s74 offen offset:0 nt lds
    buffer_load_dwordx4 v2, s[44:47], s74 offen offset:1024 nt lds
    buffer_load_dwordx4 v3, s[44:47], s74 offen offset:2048 nt lds
    buffer_load_dwordx4 v4, s[44:47], s74 offen offset:3072 nt lds
    s_load_dword s4, s[30:31], 0
    s_waitcnt vmcnt(16)
    ds_read_b128 v[100:103], v7 offset:0
    ds_read_b128 v[104:107], v8 offset:0
    ds_read_b128 v[108:111], v9 offset:0
    ds_read_b128 v[112:115], v10 offset:0
    ds_read_b128 v[116:119], v7 offset:4096
    ds_read_b128 v[120:123], v8 offset:4096
    ds_read_b128 v[124:127], v9 offset:4096
    ds_read_b128 v[128:131], v10 offset:4096
    s_waitcnt lgkmcnt(0)
    s_add_u32 m0, s68, 0
    s_mov_b32 s74, 24576
    buffer_load_dwordx4 v1, s[44:47], s74 offen offset:0 nt lds
    buffer_load_dwordx4 v2, s[44:47], s74 offen offset:1024 nt lds
    buffer_load_dwordx4 v3, s[44:47], s74 offen offset:2048 nt lds
    buffer_load_dwordx4 v4, s[44:47], s74 offen offset:3072 nt lds
    s_add_u32 m0, s68, 4096
    s_mov_b32 s74, 28672
    buffer_load_dwordx4 v1, s[44:47], s74 offen offset:0 nt lds
    buffer_load_dwordx4 v2, s[44:47], s74 offen offset:1024 nt lds
    buffer_load_dwordx4 v3, s[44:47], s74 offen offset:2048 nt lds
    buffer_load_dwordx4 v4, s[44:47], s74 offen offset:3072 nt lds
    s_waitcnt vmcnt(16)
    ds_read_b128 v[140:143], v7 offset:8192
    ds_read_b128 v[144:147], v8 offset:8192
    ds_read_b128 v[148:151], v9 offset:8192
    ds_read_b128 v[152:155], v10 offset:8192
    ds_read_b128 v[156:159], v7 offset:12288
    ds_read_b128 v[160:163], v8 offset:12288
    ds_read_b128 v[164:167], v9 offset:12288
    ds_read_b128 v[168:171], v10 offset:12288
    s_waitcnt lgkmcnt(0)
    s_add_u32 m0, s68, 8192
    s_mov_b32 s74, 32768
    buffer_load_dwordx4 v1, s[44:47], s74 offen offset:0 nt lds
    buffer_load_dwordx4 v2, s[44:47], s74 offen offset:1024 nt lds
    buffer_load_dwordx4 v3, s[44:47], s74 offen offset:2048 nt lds
    buffer_load_dwordx4 v4, s[44:47], s74 offen offset:3072 nt lds
    s_add_u32 m0, s68, 12288
    s_mov_b32 s74, 36864
    buffer_load_dwordx4 v1, s[44:47], s74 offen offset:0 nt lds
    buffer_load_dwordx4 v2, s[44:47], s74 offen offset:1024 nt lds
    buffer_load_dwordx4 v3, s[44:47], s74 offen offset:2048 nt lds
    buffer_load_dwordx4 v4, s[44:47], s74 offen offset:3072 nt lds
    s_waitcnt vmcnt(16)
    ds_read_b128 v[180:183], v7 offset:16384
    ds_read_b128 v[184:187], v8 offset:16384
    ds_read_b128 v[188:191], v9 offset:16384
    ds_read_b128 v[192:195], v10 offset:16384
    ds_read_b128 v[196:199], v7 offset:20480
    ds_read_b128 v[200:203], v8 offset:20480
    ds_read_b128 v[204:207], v9 offset:20480
    ds_read_b128 v[208:211], v10 offset:20480
    s_waitcnt lgkmcnt(0)
    s_add_u32 m0, s68, 16384
    s_mov_b32 s74, 40960
    buffer_load_dwordx4 v1, s[44:47], s74 offen offset:0 nt lds
    buffer_load_dwordx4 v2, s[44:47], s74 offen offset:1024 nt lds
    buffer_load_dwordx4 v3, s[44:47], s74 offen offset:2048 nt lds
    buffer_load_dwordx4 v4, s[44:47], s74 offen offset:3072 nt lds
    s_add_u32 m0, s68, 20480
    s_mov_b32 s74, 45056
    buffer_load_dwordx4 v1, s[44:47], s74 offen offset:0 nt lds
    buffer_load_dwordx4 v2, s[44:47], s74 offen offset:1024 nt lds
    buffer_load_dwordx4 v3, s[44:47], s74 offen offset:2048 nt lds
    buffer_load_dwordx4 v4, s[44:47], s74 offen offset:3072 nt lds
    s_waitcnt vmcnt(16)
    ds_read_b128 v[212:215], v7 offset:0
    ds_read_b128 v[216:219], v8 offset:0
    ds_read_b128 v[220:223], v9 offset:0
    ds_read_b128 v[224:227], v10 offset:0
    ds_read_b128 v[228:231], v7 offset:4096
    ds_read_b128 v[232:235], v8 offset:4096
    ds_read_b128 v[236:239], v9 offset:4096
    ds_read_b128 v[240:243], v10 offset:4096
    s_waitcnt lgkmcnt(0)
    s_add_u32 m0, s68, 0
    s_mov_b32 s74, 49152
    buffer_load_dwordx4 v1, s[44:47], s74 offen offset:0 nt lds
    buffer_load_dwordx4 v2, s[44:47], s74 offen offset:1024 nt lds
    buffer_load_dwordx4 v3, s[44:47], s74 offen offset:2048 nt lds
    buffer_load_dwordx4 v4, s[44:47], s74 offen offset:3072 nt lds
    s_add_u32 m0, s68, 4096
    s_mov_b32 s74, 53248
    buffer_load_dwordx4 v1, s[44:47], s74 offen offset:0 nt lds
    buffer_load_dwordx4 v2, s[44:47], s74 offen offset:1024 nt lds
    buffer_load_dwordx4 v3, s[44:47], s74 offen offset:2048 nt lds
    buffer_load_dwordx4 v4, s[44:47], s74 offen offset:3072 nt lds
    s_waitcnt vmcnt(16)
    ds_read_b128 v[36:39], v7 offset:8192
    ds_read_b128 v[40:43], v8 offset:8192
    ds_read_b128 v[44:47], v9 offset:8192
    ds_read_b128 v[48:51], v10 offset:8192
    ds_read_b128 v[52:55], v7 offset:12288
    ds_read_b128 v[56:59], v8 offset:12288
    ds_read_b128 v[60:63], v9 offset:12288
    ds_read_b128 v[64:67], v10 offset:12288
    s_waitcnt lgkmcnt(0)
    s_add_u32 m0, s68, 8192
    s_mov_b32 s74, 0
    buffer_load_dwordx4 v5, s[48:51], s74 offen offset:0 nt lds
    buffer_load_dwordx4 v6, s[48:51], s74 offen offset:1024 nt lds
    buffer_load_dwordx4 v5, s[48:51], s74 offen offset:2048 nt lds
    buffer_load_dwordx4 v6, s[48:51], s74 offen offset:3072 nt lds
    s_add_u32 m0, s68, 12288
    s_mov_b32 s74, 4096
    buffer_load_dwordx4 v5, s[48:51], s74 offen offset:0 nt lds
    buffer_load_dwordx4 v6, s[48:51], s74 offen offset:1024 nt lds
    buffer_load_dwordx4 v5, s[48:51], s74 offen offset:2048 nt lds
    buffer_load_dwordx4 v6, s[48:51], s74 offen offset:3072 nt lds
    s_waitcnt lgkmcnt(0)
    s_add_u32 s16, s4, 1
    s_and_b32 s16, s16, 0xff
    s_add_u32 s17, s4, 65
    s_and_b32 s17, s17, 0xff
    s_add_u32 s18, s4, 129
    s_and_b32 s18, s18, 0xff
    s_add_u32 s19, s4, 193
    s_and_b32 s19, s19, 0xff
    v_and_b32 v174, 15, v0
    v_lshlrev_b32 v244, 9, v174
    v_lshrrev_b32 v176, 4, v0
    v_lshlrev_b32 v176, 4, v176
    v_add_u32 v244, v244, v176
    v_add_u32 v244, s68, v244
    v_lshlrev_b32 v245, 3, v0
    v_add_u32 v245, s68, v245
    v_and_b32 v246, 31, v0
    v_lshlrev_b32 v246, 4, v246
    s_lshl_b32 s66, s3, 9
    v_add_u32 v246, s66, v246
    v_add_u32 v247, 49152, v246
    s_lshl_b32 s67, s3, 3
    v_mov_b32 v248, s67
    v_add_u32 v249, 49152, v248
    s_lshl_b32 s66, s37, 4
    s_add_u32 s66, s66, s36
    s_lshl_b32 s66, s66, 2
    s_add_u32 s66, s66, s3
    s_lshl_b32 s66, s66, 10
    s_add_u32 s66, s66, 1048576
    v_lshlrev_b32 v250, 4, v0
    v_add_u32 v250, s66, v250
    v_and_b32 v251, 3, v0
    v_lshlrev_b32 v251, 8, v251
    v_add_u32 v251, v251, v176
    v_add_u32 v251, 98304, v251
    v_mov_b32 v252, s16
    v_mov_b32 v253, s17
    v_mov_b32 v254, s18
    v_mov_b32 v255, s19
    s_barrier
    ds_read_b128 v[20:23], v251 offset:0
    ds_read_b128 v[24:27], v251 offset:64
    ds_read_b128 v[28:31], v251 offset:128
    ds_read_b128 v[32:35], v251 offset:192
    s_waitcnt lgkmcnt(0)
    v_mfma_f32_16x16x32_bf16 v[68:71], v[100:103], v[20:23], 0
    v_mfma_f32_16x16x32_bf16 v[72:75], v[116:119], v[20:23], 0
    v_mfma_f32_16x16x32_bf16 v[68:71], v[104:107], v[24:27], v[68:71]
    v_mfma_f32_16x16x32_bf16 v[72:75], v[120:123], v[24:27], v[72:75]
    v_mfma_f32_16x16x32_bf16 v[68:71], v[108:111], v[28:31], v[68:71]
    v_mfma_f32_16x16x32_bf16 v[72:75], v[124:127], v[28:31], v[72:75]
    v_mfma_f32_16x16x32_bf16 v[68:71], v[112:115], v[32:35], v[68:71]
    v_mfma_f32_16x16x32_bf16 v[72:75], v[128:131], v[32:35], v[72:75]
    v_mfma_f32_16x16x32_bf16 v[76:79], v[140:143], v[20:23], 0
    v_mfma_f32_16x16x32_bf16 v[80:83], v[156:159], v[20:23], 0
    v_mfma_f32_16x16x32_bf16 v[76:79], v[144:147], v[24:27], v[76:79]
    v_mfma_f32_16x16x32_bf16 v[80:83], v[160:163], v[24:27], v[80:83]
    v_mfma_f32_16x16x32_bf16 v[76:79], v[148:151], v[28:31], v[76:79]
    v_mfma_f32_16x16x32_bf16 v[80:83], v[164:167], v[28:31], v[80:83]
    v_mfma_f32_16x16x32_bf16 v[76:79], v[152:155], v[32:35], v[76:79]
    v_mfma_f32_16x16x32_bf16 v[80:83], v[168:171], v[32:35], v[80:83]
    v_mfma_f32_16x16x32_bf16 v[84:87], v[180:183], v[20:23], 0
    v_mfma_f32_16x16x32_bf16 v[88:91], v[196:199], v[20:23], 0
    v_mfma_f32_16x16x32_bf16 v[84:87], v[184:187], v[24:27], v[84:87]
    v_mfma_f32_16x16x32_bf16 v[88:91], v[200:203], v[24:27], v[88:91]
    v_mfma_f32_16x16x32_bf16 v[84:87], v[188:191], v[28:31], v[84:87]
    v_mfma_f32_16x16x32_bf16 v[88:91], v[204:207], v[28:31], v[88:91]
    v_mfma_f32_16x16x32_bf16 v[84:87], v[192:195], v[32:35], v[84:87]
    v_mfma_f32_16x16x32_bf16 v[88:91], v[208:211], v[32:35], v[88:91]
    v_mfma_f32_16x16x32_bf16 v[92:95], v[212:215], v[20:23], 0
    v_mfma_f32_16x16x32_bf16 v[96:99], v[228:231], v[20:23], 0
    v_mfma_f32_16x16x32_bf16 v[92:95], v[216:219], v[24:27], v[92:95]
    v_mfma_f32_16x16x32_bf16 v[96:99], v[232:235], v[24:27], v[96:99]
    v_mfma_f32_16x16x32_bf16 v[92:95], v[220:223], v[28:31], v[92:95]
    v_mfma_f32_16x16x32_bf16 v[96:99], v[236:239], v[28:31], v[96:99]
    v_mfma_f32_16x16x32_bf16 v[92:95], v[224:227], v[32:35], v[92:95]
    v_mfma_f32_16x16x32_bf16 v[96:99], v[240:243], v[32:35], v[96:99]
    v_mfma_f32_16x16x32_bf16 v[100:103], v[36:39], v[20:23], 0
    v_mfma_f32_16x16x32_bf16 v[104:107], v[52:55], v[20:23], 0
    v_mfma_f32_16x16x32_bf16 v[100:103], v[40:43], v[24:27], v[100:103]
    v_mfma_f32_16x16x32_bf16 v[104:107], v[56:59], v[24:27], v[104:107]
    v_mfma_f32_16x16x32_bf16 v[100:103], v[44:47], v[28:31], v[100:103]
    v_mfma_f32_16x16x32_bf16 v[104:107], v[60:63], v[28:31], v[104:107]
    v_mfma_f32_16x16x32_bf16 v[100:103], v[48:51], v[32:35], v[100:103]
    v_mfma_f32_16x16x32_bf16 v[104:107], v[64:67], v[32:35], v[104:107]
    s_waitcnt vmcnt(16)
    ds_read_b128 v[36:39], v7 offset:16384
    ds_read_b128 v[40:43], v8 offset:16384
    ds_read_b128 v[44:47], v9 offset:16384
    ds_read_b128 v[48:51], v10 offset:16384
    ds_read_b128 v[52:55], v7 offset:20480
    ds_read_b128 v[56:59], v8 offset:20480
    ds_read_b128 v[60:63], v9 offset:20480
    ds_read_b128 v[64:67], v10 offset:20480
    s_waitcnt lgkmcnt(0)
    s_add_u32 m0, s68, 16384
    s_mov_b32 s74, 8192
    buffer_load_dwordx4 v5, s[48:51], s74 offen offset:0 nt lds
    buffer_load_dwordx4 v6, s[48:51], s74 offen offset:1024 nt lds
    buffer_load_dwordx4 v5, s[48:51], s74 offen offset:2048 nt lds
    buffer_load_dwordx4 v6, s[48:51], s74 offen offset:3072 nt lds
    s_add_u32 m0, s68, 20480
    s_mov_b32 s74, 12288
    buffer_load_dwordx4 v5, s[48:51], s74 offen offset:0 nt lds
    buffer_load_dwordx4 v6, s[48:51], s74 offen offset:1024 nt lds
    buffer_load_dwordx4 v5, s[48:51], s74 offen offset:2048 nt lds
    buffer_load_dwordx4 v6, s[48:51], s74 offen offset:3072 nt lds
    v_mfma_f32_16x16x32_bf16 v[108:111], v[36:39], v[20:23], 0
    v_mfma_f32_16x16x32_bf16 v[112:115], v[52:55], v[20:23], 0
    v_mfma_f32_16x16x32_bf16 v[108:111], v[40:43], v[24:27], v[108:111]
    v_mfma_f32_16x16x32_bf16 v[112:115], v[56:59], v[24:27], v[112:115]
    v_mfma_f32_16x16x32_bf16 v[108:111], v[44:47], v[28:31], v[108:111]
    v_mfma_f32_16x16x32_bf16 v[112:115], v[60:63], v[28:31], v[112:115]
    v_mfma_f32_16x16x32_bf16 v[108:111], v[48:51], v[32:35], v[108:111]
    v_mfma_f32_16x16x32_bf16 v[112:115], v[64:67], v[32:35], v[112:115]
    s_waitcnt vmcnt(16)
    ds_read_b128 v[36:39], v7 offset:0
    ds_read_b128 v[40:43], v8 offset:0
    ds_read_b128 v[44:47], v9 offset:0
    ds_read_b128 v[48:51], v10 offset:0
    ds_read_b128 v[52:55], v7 offset:4096
    ds_read_b128 v[56:59], v8 offset:4096
    ds_read_b128 v[60:63], v9 offset:4096
    ds_read_b128 v[64:67], v10 offset:4096
    s_waitcnt lgkmcnt(0)
    s_add_u32 m0, s68, 0
    s_mov_b32 s74, 16384
    buffer_load_dwordx4 v5, s[48:51], s74 offen offset:0 nt lds
    buffer_load_dwordx4 v6, s[48:51], s74 offen offset:1024 nt lds
    buffer_load_dwordx4 v5, s[48:51], s74 offen offset:2048 nt lds
    buffer_load_dwordx4 v6, s[48:51], s74 offen offset:3072 nt lds
    s_add_u32 m0, s68, 4096
    s_mov_b32 s74, 20480
    buffer_load_dwordx4 v5, s[48:51], s74 offen offset:0 nt lds
    buffer_load_dwordx4 v6, s[48:51], s74 offen offset:1024 nt lds
    buffer_load_dwordx4 v5, s[48:51], s74 offen offset:2048 nt lds
    buffer_load_dwordx4 v6, s[48:51], s74 offen offset:3072 nt lds
    v_mfma_f32_16x16x32_bf16 v[116:119], v[36:39], v[20:23], 0
    v_mfma_f32_16x16x32_bf16 v[120:123], v[52:55], v[20:23], 0
    v_mfma_f32_16x16x32_bf16 v[116:119], v[40:43], v[24:27], v[116:119]
    v_mfma_f32_16x16x32_bf16 v[120:123], v[56:59], v[24:27], v[120:123]
    v_mfma_f32_16x16x32_bf16 v[116:119], v[44:47], v[28:31], v[116:119]
    v_mfma_f32_16x16x32_bf16 v[120:123], v[60:63], v[28:31], v[120:123]
    v_mfma_f32_16x16x32_bf16 v[116:119], v[48:51], v[32:35], v[116:119]
    v_mfma_f32_16x16x32_bf16 v[120:123], v[64:67], v[32:35], v[120:123]
    s_nop 7
    v_max3_f32 v172, v68, v69, v70
    v_max3_f32 v174, v71, v72, v73
    v_max3_f32 v172, v172, v74, v75
    v_max3_f32 v174, v174, v76, v77
    v_max3_f32 v172, v172, v78, v79
    v_max3_f32 v174, v174, v80, v81
    v_max3_f32 v172, v172, v82, v83
    v_max3_f32 v174, v174, v84, v85
    v_max3_f32 v172, v172, v86, v87
    v_max3_f32 v174, v174, v88, v89
    v_max3_f32 v172, v172, v90, v91
    v_max3_f32 v174, v174, v92, v93
    v_max3_f32 v172, v172, v94, v95
    v_max3_f32 v174, v174, v96, v97
    v_max3_f32 v172, v172, v98, v99
    v_max3_f32 v174, v174, v100, v101
    v_max3_f32 v172, v172, v102, v103
    v_max3_f32 v174, v174, v104, v105
    v_max3_f32 v172, v172, v106, v107
    v_max3_f32 v174, v174, v108, v109
    v_max3_f32 v172, v172, v110, v111
    v_max3_f32 v174, v174, v112, v113
    v_max3_f32 v172, v172, v114, v115
    v_max3_f32 v174, v174, v116, v117
    v_max3_f32 v172, v172, v118, v119
    v_max3_f32 v174, v174, v120, v121
    v_max3_f32 v172, v172, v122, v123
    v_max_f32 v172, v172, v174
    v_mov_b32 v174, v172
    s_nop 1
    v_permlane16_swap_b32 v172, v174
    s_nop 1
    v_max_f32 v172, v172, v174
    v_mov_b32 v174, v172
    s_nop 1
    v_permlane32_swap_b32 v172, v174
    s_nop 1
    v_max_f32 v172, v172, v174
    v_mul_f32 v175, s65, v172
    v_mov_b32 v173, 0
    v_mov_b32 v176, 0
    v_fma_f32 v68, v68, s64, v175
    v_fma_f32 v69, v69, s64, v175
    v_fma_f32 v70, v70, s64, v175
    v_fma_f32 v71, v71, s64, v175
    v_fma_f32 v72, v72, s64, v175
    v_fma_f32 v73, v73, s64, v175
    v_fma_f32 v74, v74, s64, v175
    v_fma_f32 v75, v75, s64, v175
    v_fma_f32 v76, v76, s64, v175
    v_fma_f32 v77, v77, s64, v175
    v_fma_f32 v78, v78, s64, v175
    v_fma_f32 v79, v79, s64, v175
    v_fma_f32 v80, v80, s64, v175
    v_fma_f32 v81, v81, s64, v175
    v_fma_f32 v82, v82, s64, v175
    v_fma_f32 v83, v83, s64, v175
    v_fma_f32 v84, v84, s64, v175
    v_fma_f32 v85, v85, s64, v175
    v_fma_f32 v86, v86, s64, v175
    v_fma_f32 v87, v87, s64, v175
    v_fma_f32 v88, v88, s64, v175
    v_fma_f32 v89, v89, s64, v175
    v_fma_f32 v90, v90, s64, v175
    v_fma_f32 v91, v91, s64, v175
    v_fma_f32 v92, v92, s64, v175
    v_fma_f32 v93, v93, s64, v175
    v_fma_f32 v94, v94, s64, v175
    v_fma_f32 v95, v95, s64, v175
    v_fma_f32 v96, v96, s64, v175
    v_fma_f32 v97, v97, s64, v175
    v_fma_f32 v98, v98, s64, v175
    v_fma_f32 v99, v99, s64, v175
    v_fma_f32 v100, v100, s64, v175
    v_fma_f32 v101, v101, s64, v175
    v_fma_f32 v102, v102, s64, v175
    v_fma_f32 v103, v103, s64, v175
    v_fma_f32 v104, v104, s64, v175
    v_fma_f32 v105, v105, s64, v175
    v_fma_f32 v106, v106, s64, v175
    v_fma_f32 v107, v107, s64, v175
    v_fma_f32 v108, v108, s64, v175
    v_fma_f32 v109, v109, s64, v175
    v_fma_f32 v110, v110, s64, v175
    v_fma_f32 v111, v111, s64, v175
    v_fma_f32 v112, v112, s64, v175
    v_fma_f32 v113, v113, s64, v175
    v_fma_f32 v114, v114, s64, v175
    v_fma_f32 v115, v115, s64, v175
    v_fma_f32 v116, v116, s64, v175
    v_fma_f32 v117, v117, s64, v175
    v_fma_f32 v118, v118, s64, v175
    v_fma_f32 v119, v119, s64, v175
    v_fma_f32 v120, v120, s64, v175
    v_fma_f32 v121, v121, s64, v175
    v_fma_f32 v122, v122, s64, v175
    v_fma_f32 v123, v123, s64, v175
    v_exp_f32 v68, v68
    v_exp_f32 v69, v69
    v_exp_f32 v70, v70
    v_exp_f32 v71, v71
    v_exp_f32 v72, v72
    v_exp_f32 v73, v73
    v_exp_f32 v74, v74
    v_exp_f32 v75, v75
    v_exp_f32 v76, v76
    v_exp_f32 v77, v77
    v_exp_f32 v78, v78
    v_exp_f32 v79, v79
    v_exp_f32 v80, v80
    v_exp_f32 v81, v81
    v_exp_f32 v82, v82
    v_exp_f32 v83, v83
    v_exp_f32 v84, v84
    v_exp_f32 v85, v85
    v_exp_f32 v86, v86
    v_exp_f32 v87, v87
    v_exp_f32 v88, v88
    v_exp_f32 v89, v89
    v_exp_f32 v90, v90
    v_exp_f32 v91, v91
    v_exp_f32 v92, v92
    v_exp_f32 v93, v93
    v_exp_f32 v94, v94
    v_exp_f32 v95, v95
    v_exp_f32 v96, v96
    v_exp_f32 v97, v97
    v_exp_f32 v98, v98
    v_exp_f32 v99, v99
    v_exp_f32 v100, v100
    v_exp_f32 v101, v101
    v_exp_f32 v102, v102
    v_exp_f32 v103, v103
    v_exp_f32 v104, v104
    v_exp_f32 v105, v105
    v_exp_f32 v106, v106
    v_exp_f32 v107, v107
    v_exp_f32 v108, v108
    v_exp_f32 v109, v109
    v_exp_f32 v110, v110
    v_exp_f32 v111, v111
    v_exp_f32 v112, v112
    v_exp_f32 v113, v113
    v_exp_f32 v114, v114
    v_exp_f32 v115, v115
    v_exp_f32 v116, v116
    v_exp_f32 v117, v117
    v_exp_f32 v118, v118
    v_exp_f32 v119, v119
    v_exp_f32 v120, v120
    v_exp_f32 v121, v121
    v_exp_f32 v122, v122
    v_exp_f32 v123, v123
    v_add_f32 v173, v173, v68
    v_add_f32 v176, v176, v69
    v_add_f32 v173, v173, v70
    v_add_f32 v176, v176, v71
    v_add_f32 v173, v173, v72
    v_add_f32 v176, v176, v73
    v_add_f32 v173, v173, v74
    v_add_f32 v176, v176, v75
    v_add_f32 v173, v173, v76
    v_add_f32 v176, v176, v77
    v_add_f32 v173, v173, v78
    v_add_f32 v176, v176, v79
    v_add_f32 v173, v173, v80
    v_add_f32 v176, v176, v81
    v_add_f32 v173, v173, v82
    v_add_f32 v176, v176, v83
    v_add_f32 v173, v173, v84
    v_add_f32 v176, v176, v85
    v_add_f32 v173, v173, v86
    v_add_f32 v176, v176, v87
    v_add_f32 v173, v173, v88
    v_add_f32 v176, v176, v89
    v_add_f32 v173, v173, v90
    v_add_f32 v176, v176, v91
    v_add_f32 v173, v173, v92
    v_add_f32 v176, v176, v93
    v_add_f32 v173, v173, v94
    v_add_f32 v176, v176, v95
    v_add_f32 v173, v173, v96
    v_add_f32 v176, v176, v97
    v_add_f32 v173, v173, v98
    v_add_f32 v176, v176, v99
    v_add_f32 v173, v173, v100
    v_add_f32 v176, v176, v101
    v_add_f32 v173, v173, v102
    v_add_f32 v176, v176, v103
    v_add_f32 v173, v173, v104
    v_add_f32 v176, v176, v105
    v_add_f32 v173, v173, v106
    v_add_f32 v176, v176, v107
    v_add_f32 v173, v173, v108
    v_add_f32 v176, v176, v109
    v_add_f32 v173, v173, v110
    v_add_f32 v176, v176, v111
    v_add_f32 v173, v173, v112
    v_add_f32 v176, v176, v113
    v_add_f32 v173, v173, v114
    v_add_f32 v176, v176, v115
    v_add_f32 v173, v173, v116
    v_add_f32 v176, v176, v117
    v_add_f32 v173, v173, v118
    v_add_f32 v176, v176, v119
    v_add_f32 v173, v173, v120
    v_add_f32 v176, v176, v121
    v_add_f32 v173, v173, v122
    v_add_f32 v176, v176, v123
    v_cvt_pk_bf16_f32 v68, v68, v69
    v_cvt_pk_bf16_f32 v69, v70, v71
    v_cvt_pk_bf16_f32 v70, v72, v73
    v_cvt_pk_bf16_f32 v71, v74, v75
    v_cvt_pk_bf16_f32 v72, v76, v77
    v_cvt_pk_bf16_f32 v73, v78, v79
    v_cvt_pk_bf16_f32 v74, v80, v81
    v_cvt_pk_bf16_f32 v75, v82, v83
    v_cvt_pk_bf16_f32 v76, v84, v85
    v_cvt_pk_bf16_f32 v77, v86, v87
    v_cvt_pk_bf16_f32 v78, v88, v89
    v_cvt_pk_bf16_f32 v79, v90, v91
    v_cvt_pk_bf16_f32 v80, v92, v93
    v_cvt_pk_bf16_f32 v81, v94, v95
    v_cvt_pk_bf16_f32 v82, v96, v97
    v_cvt_pk_bf16_f32 v83, v98, v99
    v_cvt_pk_bf16_f32 v84, v100, v101
    v_cvt_pk_bf16_f32 v85, v102, v103
    v_cvt_pk_bf16_f32 v86, v104, v105
    v_cvt_pk_bf16_f32 v87, v106, v107
    v_cvt_pk_bf16_f32 v88, v108, v109
    v_cvt_pk_bf16_f32 v89, v110, v111
    v_cvt_pk_bf16_f32 v90, v112, v113
    v_cvt_pk_bf16_f32 v91, v114, v115
    v_cvt_pk_bf16_f32 v92, v116, v117
    v_cvt_pk_bf16_f32 v93, v118, v119
    v_cvt_pk_bf16_f32 v94, v120, v121
    v_cvt_pk_bf16_f32 v95, v122, v123
    v_add_f32 v173, v173, v176
    v_mov_b32 v174, v173
    s_nop 1
    v_permlane16_swap_b32 v173, v174
    s_nop 1
    v_add_f32 v173, v173, v174
    v_mov_b32 v174, v173
    s_nop 1
    v_permlane32_swap_b32 v173, v174
    s_nop 1
    v_add_f32 v173, v173, v174
    s_waitcnt vmcnt(16)
    ds_read_b64_tr_b16 v[36:37], v11 offset:8192
    ds_read_b64_tr_b16 v[38:39], v11 offset:12288
    ds_read_b64_tr_b16 v[40:41], v12 offset:8192
    ds_read_b64_tr_b16 v[42:43], v12 offset:12288
    ds_read_b64_tr_b16 v[44:45], v13 offset:8192
    ds_read_b64_tr_b16 v[46:47], v13 offset:12288
    ds_read_b64_tr_b16 v[48:49], v14 offset:8192
    ds_read_b64_tr_b16 v[50:51], v14 offset:12288
    ds_read_b64_tr_b16 v[52:53], v15 offset:8192
    ds_read_b64_tr_b16 v[54:55], v15 offset:12288
    ds_read_b64_tr_b16 v[56:57], v16 offset:8192
    ds_read_b64_tr_b16 v[58:59], v16 offset:12288
    ds_read_b64_tr_b16 v[60:61], v17 offset:8192
    ds_read_b64_tr_b16 v[62:63], v17 offset:12288
    ds_read_b64_tr_b16 v[64:65], v18 offset:8192
    ds_read_b64_tr_b16 v[66:67], v18 offset:12288
    s_waitcnt lgkmcnt(0)
    s_add_u32 m0, s68, 8192
    s_mov_b32 s74, 24576
    buffer_load_dwordx4 v5, s[48:51], s74 offen offset:0 nt lds
    buffer_load_dwordx4 v6, s[48:51], s74 offen offset:1024 nt lds
    buffer_load_dwordx4 v5, s[48:51], s74 offen offset:2048 nt lds
    buffer_load_dwordx4 v6, s[48:51], s74 offen offset:3072 nt lds
    s_add_u32 m0, s68, 12288
    s_mov_b32 s74, 28672
    buffer_load_dwordx4 v5, s[48:51], s74 offen offset:0 nt lds
    buffer_load_dwordx4 v6, s[48:51], s74 offen offset:1024 nt lds
    buffer_load_dwordx4 v5, s[48:51], s74 offen offset:2048 nt lds
    buffer_load_dwordx4 v6, s[48:51], s74 offen offset:3072 nt lds
    v_mfma_f32_16x16x32_bf16 v[140:143], v[36:39], v[68:71], 0
    v_mfma_f32_16x16x32_bf16 v[144:147], v[40:43], v[68:71], 0
    v_mfma_f32_16x16x32_bf16 v[148:151], v[44:47], v[68:71], 0
    v_mfma_f32_16x16x32_bf16 v[152:155], v[48:51], v[68:71], 0
    v_mfma_f32_16x16x32_bf16 v[156:159], v[52:55], v[68:71], 0
    v_mfma_f32_16x16x32_bf16 v[160:163], v[56:59], v[68:71], 0
    v_mfma_f32_16x16x32_bf16 v[164:167], v[60:63], v[68:71], 0
    v_mfma_f32_16x16x32_bf16 v[168:171], v[64:67], v[68:71], 0
    s_waitcnt vmcnt(16)
    ds_read_b64_tr_b16 v[36:37], v11 offset:16384
    ds_read_b64_tr_b16 v[38:39], v11 offset:20480
    ds_read_b64_tr_b16 v[40:41], v12 offset:16384
    ds_read_b64_tr_b16 v[42:43], v12 offset:20480
    ds_read_b64_tr_b16 v[44:45], v13 offset:16384
    ds_read_b64_tr_b16 v[46:47], v13 offset:20480
    ds_read_b64_tr_b16 v[48:49], v14 offset:16384
    ds_read_b64_tr_b16 v[50:51], v14 offset:20480
    ds_read_b64_tr_b16 v[52:53], v15 offset:16384
    ds_read_b64_tr_b16 v[54:55], v15 offset:20480
    ds_read_b64_tr_b16 v[56:57], v16 offset:16384
    ds_read_b64_tr_b16 v[58:59], v16 offset:20480
    ds_read_b64_tr_b16 v[60:61], v17 offset:16384
    ds_read_b64_tr_b16 v[62:63], v17 offset:20480
    ds_read_b64_tr_b16 v[64:65], v18 offset:16384
    ds_read_b64_tr_b16 v[66:67], v18 offset:20480
    s_waitcnt lgkmcnt(0)
    s_add_u32 m0, s68, 16384
    s_mov_b32 s74, 32768
    buffer_load_dwordx4 v5, s[48:51], s74 offen offset:0 nt lds
    buffer_load_dwordx4 v6, s[48:51], s74 offen offset:1024 nt lds
    buffer_load_dwordx4 v5, s[48:51], s74 offen offset:2048 nt lds
    buffer_load_dwordx4 v6, s[48:51], s74 offen offset:3072 nt lds
    s_add_u32 m0, s68, 20480
    s_mov_b32 s74, 36864
    buffer_load_dwordx4 v5, s[48:51], s74 offen offset:0 nt lds
    buffer_load_dwordx4 v6, s[48:51], s74 offen offset:1024 nt lds
    buffer_load_dwordx4 v5, s[48:51], s74 offen offset:2048 nt lds
    buffer_load_dwordx4 v6, s[48:51], s74 offen offset:3072 nt lds
    v_mfma_f32_16x16x32_bf16 v[140:143], v[36:39], v[72:75], v[140:143]
    v_mfma_f32_16x16x32_bf16 v[144:147], v[40:43], v[72:75], v[144:147]
    v_mfma_f32_16x16x32_bf16 v[148:151], v[44:47], v[72:75], v[148:151]
    v_mfma_f32_16x16x32_bf16 v[152:155], v[48:51], v[72:75], v[152:155]
    v_mfma_f32_16x16x32_bf16 v[156:159], v[52:55], v[72:75], v[156:159]
    v_mfma_f32_16x16x32_bf16 v[160:163], v[56:59], v[72:75], v[160:163]
    v_mfma_f32_16x16x32_bf16 v[164:167], v[60:63], v[72:75], v[164:167]
    v_mfma_f32_16x16x32_bf16 v[168:171], v[64:67], v[72:75], v[168:171]
    s_waitcnt vmcnt(16)
    ds_read_b64_tr_b16 v[36:37], v11 offset:0
    ds_read_b64_tr_b16 v[38:39], v11 offset:4096
    ds_read_b64_tr_b16 v[40:41], v12 offset:0
    ds_read_b64_tr_b16 v[42:43], v12 offset:4096
    ds_read_b64_tr_b16 v[44:45], v13 offset:0
    ds_read_b64_tr_b16 v[46:47], v13 offset:4096
    ds_read_b64_tr_b16 v[48:49], v14 offset:0
    ds_read_b64_tr_b16 v[50:51], v14 offset:4096
    ds_read_b64_tr_b16 v[52:53], v15 offset:0
    ds_read_b64_tr_b16 v[54:55], v15 offset:4096
    ds_read_b64_tr_b16 v[56:57], v16 offset:0
    ds_read_b64_tr_b16 v[58:59], v16 offset:4096
    ds_read_b64_tr_b16 v[60:61], v17 offset:0
    ds_read_b64_tr_b16 v[62:63], v17 offset:4096
    ds_read_b64_tr_b16 v[64:65], v18 offset:0
    ds_read_b64_tr_b16 v[66:67], v18 offset:4096
    s_waitcnt lgkmcnt(0)
    s_add_u32 m0, s68, 0
    s_mov_b32 s74, 40960
    buffer_load_dwordx4 v5, s[48:51], s74 offen offset:0 nt lds
    buffer_load_dwordx4 v6, s[48:51], s74 offen offset:1024 nt lds
    buffer_load_dwordx4 v5, s[48:51], s74 offen offset:2048 nt lds
    buffer_load_dwordx4 v6, s[48:51], s74 offen offset:3072 nt lds
    s_add_u32 m0, s68, 4096
    s_mov_b32 s74, 45056
    buffer_load_dwordx4 v5, s[48:51], s74 offen offset:0 nt lds
    buffer_load_dwordx4 v6, s[48:51], s74 offen offset:1024 nt lds
    buffer_load_dwordx4 v5, s[48:51], s74 offen offset:2048 nt lds
    buffer_load_dwordx4 v6, s[48:51], s74 offen offset:3072 nt lds
    v_mfma_f32_16x16x32_bf16 v[140:143], v[36:39], v[76:79], v[140:143]
    v_mfma_f32_16x16x32_bf16 v[144:147], v[40:43], v[76:79], v[144:147]
    v_mfma_f32_16x16x32_bf16 v[148:151], v[44:47], v[76:79], v[148:151]
    v_mfma_f32_16x16x32_bf16 v[152:155], v[48:51], v[76:79], v[152:155]
    v_mfma_f32_16x16x32_bf16 v[156:159], v[52:55], v[76:79], v[156:159]
    v_mfma_f32_16x16x32_bf16 v[160:163], v[56:59], v[76:79], v[160:163]
    v_mfma_f32_16x16x32_bf16 v[164:167], v[60:63], v[76:79], v[164:167]
    v_mfma_f32_16x16x32_bf16 v[168:171], v[64:67], v[76:79], v[168:171]
    s_waitcnt vmcnt(16)
    ds_read_b64_tr_b16 v[36:37], v11 offset:8192
    ds_read_b64_tr_b16 v[38:39], v11 offset:12288
    ds_read_b64_tr_b16 v[40:41], v12 offset:8192
    ds_read_b64_tr_b16 v[42:43], v12 offset:12288
    ds_read_b64_tr_b16 v[44:45], v13 offset:8192
    ds_read_b64_tr_b16 v[46:47], v13 offset:12288
    ds_read_b64_tr_b16 v[48:49], v14 offset:8192
    ds_read_b64_tr_b16 v[50:51], v14 offset:12288
    ds_read_b64_tr_b16 v[52:53], v15 offset:8192
    ds_read_b64_tr_b16 v[54:55], v15 offset:12288
    ds_read_b64_tr_b16 v[56:57], v16 offset:8192
    ds_read_b64_tr_b16 v[58:59], v16 offset:12288
    ds_read_b64_tr_b16 v[60:61], v17 offset:8192
    ds_read_b64_tr_b16 v[62:63], v17 offset:12288
    ds_read_b64_tr_b16 v[64:65], v18 offset:8192
    ds_read_b64_tr_b16 v[66:67], v18 offset:12288
    s_waitcnt lgkmcnt(0)
    s_add_u32 m0, s68, 8192
    s_mov_b32 s74, 49152
    buffer_load_dwordx4 v5, s[48:51], s74 offen offset:0 nt lds
    buffer_load_dwordx4 v6, s[48:51], s74 offen offset:1024 nt lds
    buffer_load_dwordx4 v5, s[48:51], s74 offen offset:2048 nt lds
    buffer_load_dwordx4 v6, s[48:51], s74 offen offset:3072 nt lds
    s_add_u32 m0, s68, 12288
    s_mov_b32 s74, 53248
    buffer_load_dwordx4 v5, s[48:51], s74 offen offset:0 nt lds
    buffer_load_dwordx4 v6, s[48:51], s74 offen offset:1024 nt lds
    buffer_load_dwordx4 v5, s[48:51], s74 offen offset:2048 nt lds
    buffer_load_dwordx4 v6, s[48:51], s74 offen offset:3072 nt lds
    v_mfma_f32_16x16x32_bf16 v[140:143], v[36:39], v[80:83], v[140:143]
    v_mfma_f32_16x16x32_bf16 v[144:147], v[40:43], v[80:83], v[144:147]
    v_mfma_f32_16x16x32_bf16 v[148:151], v[44:47], v[80:83], v[148:151]
    v_mfma_f32_16x16x32_bf16 v[152:155], v[48:51], v[80:83], v[152:155]
    v_mfma_f32_16x16x32_bf16 v[156:159], v[52:55], v[80:83], v[156:159]
    v_mfma_f32_16x16x32_bf16 v[160:163], v[56:59], v[80:83], v[160:163]
    v_mfma_f32_16x16x32_bf16 v[164:167], v[60:63], v[80:83], v[164:167]
    v_mfma_f32_16x16x32_bf16 v[168:171], v[64:67], v[80:83], v[168:171]
    s_waitcnt vmcnt(16)
    ds_read_b64_tr_b16 v[36:37], v11 offset:16384
    ds_read_b64_tr_b16 v[38:39], v11 offset:20480
    ds_read_b64_tr_b16 v[40:41], v12 offset:16384
    ds_read_b64_tr_b16 v[42:43], v12 offset:20480
    ds_read_b64_tr_b16 v[44:45], v13 offset:16384
    ds_read_b64_tr_b16 v[46:47], v13 offset:20480
    ds_read_b64_tr_b16 v[48:49], v14 offset:16384
    ds_read_b64_tr_b16 v[50:51], v14 offset:20480
    ds_read_b64_tr_b16 v[52:53], v15 offset:16384
    ds_read_b64_tr_b16 v[54:55], v15 offset:20480
    ds_read_b64_tr_b16 v[56:57], v16 offset:16384
    ds_read_b64_tr_b16 v[58:59], v16 offset:20480
    ds_read_b64_tr_b16 v[60:61], v17 offset:16384
    ds_read_b64_tr_b16 v[62:63], v17 offset:20480
    ds_read_b64_tr_b16 v[64:65], v18 offset:16384
    ds_read_b64_tr_b16 v[66:67], v18 offset:20480
    s_waitcnt lgkmcnt(0)
    v_mfma_f32_16x16x32_bf16 v[140:143], v[36:39], v[84:87], v[140:143]
    v_mfma_f32_16x16x32_bf16 v[144:147], v[40:43], v[84:87], v[144:147]
    v_mfma_f32_16x16x32_bf16 v[148:151], v[44:47], v[84:87], v[148:151]
    v_mfma_f32_16x16x32_bf16 v[152:155], v[48:51], v[84:87], v[152:155]
    v_mfma_f32_16x16x32_bf16 v[156:159], v[52:55], v[84:87], v[156:159]
    v_mfma_f32_16x16x32_bf16 v[160:163], v[56:59], v[84:87], v[160:163]
    v_mfma_f32_16x16x32_bf16 v[164:167], v[60:63], v[84:87], v[164:167]
    v_mfma_f32_16x16x32_bf16 v[168:171], v[64:67], v[84:87], v[168:171]
    s_waitcnt vmcnt(8)
    ds_read_b64_tr_b16 v[36:37], v11 offset:0
    ds_read_b64_tr_b16 v[38:39], v11 offset:4096
    ds_read_b64_tr_b16 v[40:41], v12 offset:0
    ds_read_b64_tr_b16 v[42:43], v12 offset:4096
    ds_read_b64_tr_b16 v[44:45], v13 offset:0
    ds_read_b64_tr_b16 v[46:47], v13 offset:4096
    ds_read_b64_tr_b16 v[48:49], v14 offset:0
    ds_read_b64_tr_b16 v[50:51], v14 offset:4096
    ds_read_b64_tr_b16 v[52:53], v15 offset:0
    ds_read_b64_tr_b16 v[54:55], v15 offset:4096
    ds_read_b64_tr_b16 v[56:57], v16 offset:0
    ds_read_b64_tr_b16 v[58:59], v16 offset:4096
    ds_read_b64_tr_b16 v[60:61], v17 offset:0
    ds_read_b64_tr_b16 v[62:63], v17 offset:4096
    ds_read_b64_tr_b16 v[64:65], v18 offset:0
    ds_read_b64_tr_b16 v[66:67], v18 offset:4096
    s_waitcnt lgkmcnt(0)
    v_mfma_f32_16x16x32_bf16 v[140:143], v[36:39], v[88:91], v[140:143]
    v_mfma_f32_16x16x32_bf16 v[144:147], v[40:43], v[88:91], v[144:147]
    v_mfma_f32_16x16x32_bf16 v[148:151], v[44:47], v[88:91], v[148:151]
    v_mfma_f32_16x16x32_bf16 v[152:155], v[48:51], v[88:91], v[152:155]
    v_mfma_f32_16x16x32_bf16 v[156:159], v[52:55], v[88:91], v[156:159]
    v_mfma_f32_16x16x32_bf16 v[160:163], v[56:59], v[88:91], v[160:163]
    v_mfma_f32_16x16x32_bf16 v[164:167], v[60:63], v[88:91], v[164:167]
    v_mfma_f32_16x16x32_bf16 v[168:171], v[64:67], v[88:91], v[168:171]
    s_waitcnt vmcnt(0)
    ds_read_b64_tr_b16 v[36:37], v11 offset:8192
    ds_read_b64_tr_b16 v[38:39], v11 offset:12288
    ds_read_b64_tr_b16 v[40:41], v12 offset:8192
    ds_read_b64_tr_b16 v[42:43], v12 offset:12288
    ds_read_b64_tr_b16 v[44:45], v13 offset:8192
    ds_read_b64_tr_b16 v[46:47], v13 offset:12288
    ds_read_b64_tr_b16 v[48:49], v14 offset:8192
    ds_read_b64_tr_b16 v[50:51], v14 offset:12288
    ds_read_b64_tr_b16 v[52:53], v15 offset:8192
    ds_read_b64_tr_b16 v[54:55], v15 offset:12288
    ds_read_b64_tr_b16 v[56:57], v16 offset:8192
    ds_read_b64_tr_b16 v[58:59], v16 offset:12288
    ds_read_b64_tr_b16 v[60:61], v17 offset:8192
    ds_read_b64_tr_b16 v[62:63], v17 offset:12288
    ds_read_b64_tr_b16 v[64:65], v18 offset:8192
    ds_read_b64_tr_b16 v[66:67], v18 offset:12288
    s_waitcnt lgkmcnt(0)
    v_mfma_f32_16x16x32_bf16 v[140:143], v[36:39], v[92:95], v[140:143]
    v_mfma_f32_16x16x32_bf16 v[144:147], v[40:43], v[92:95], v[144:147]
    v_mfma_f32_16x16x32_bf16 v[148:151], v[44:47], v[92:95], v[148:151]
    v_mfma_f32_16x16x32_bf16 v[152:155], v[48:51], v[92:95], v[152:155]
    v_mfma_f32_16x16x32_bf16 v[156:159], v[52:55], v[92:95], v[156:159]
    v_mfma_f32_16x16x32_bf16 v[160:163], v[56:59], v[92:95], v[160:163]
    v_mfma_f32_16x16x32_bf16 v[164:167], v[60:63], v[92:95], v[164:167]
    v_mfma_f32_16x16x32_bf16 v[168:171], v[64:67], v[92:95], v[168:171]
    s_branch L_scommon
L_s8:
    s_add_u32 m0, s68, 0
    s_mov_b32 s74, 0
    buffer_load_dwordx4 v1, s[44:47], s74 offen offset:0 nt lds
    buffer_load_dwordx4 v2, s[44:47], s74 offen offset:1024 nt lds
    buffer_load_dwordx4 v3, s[44:47], s74 offen offset:2048 nt lds
    buffer_load_dwordx4 v4, s[44:47], s74 offen offset:3072 nt lds
    s_add_u32 m0, s68, 4096
    s_mov_b32 s74, 4096
    buffer_load_dwordx4 v1, s[44:47], s74 offen offset:0 nt lds
    buffer_load_dwordx4 v2, s[44:47], s74 offen offset:1024 nt lds
    buffer_load_dwordx4 v3, s[44:47], s74 offen offset:2048 nt lds
    buffer_load_dwordx4 v4, s[44:47], s74 offen offset:3072 nt lds
    s_add_u32 m0, s68, 8192
    s_mov_b32 s74, 8192
    buffer_load_dwordx4 v1, s[44:47], s74 offen offset:0 nt lds
    buffer_load_dwordx4 v2, s[44:47], s74 offen offset:1024 nt lds
    buffer_load_dwordx4 v3, s[44:47], s74 offen offset:2048 nt lds
    buffer_load_dwordx4 v4, s[44:47], s74 offen offset:3072 nt lds
    s_add_u32 m0, s68, 12288
    s_mov_b32 s74, 12288
    buffer_load_dwordx4 v1, s[44:47], s74 offen offset:0 nt lds
    buffer_load_dwordx4 v2, s[44:47], s74 offen offset:1024 nt lds
    buffer_load_dwordx4 v3, s[44:47], s74 offen offset:2048 nt lds
    buffer_load_dwordx4 v4, s[44:47], s74 offen offset:3072 nt lds
    s_add_u32 m0, s68, 16384
    s_mov_b32 s74, 16384
    buffer_load_dwordx4 v1, s[44:47], s74 offen offset:0 nt lds
    buffer_load_dwordx4 v2, s[44:47], s74 offen offset:1024 nt lds
    buffer_load_dwordx4 v3, s[44:47], s74 offen offset:2048 nt lds
    buffer_load_dwordx4 v4, s[44:47], s74 offen offset:3072 nt lds
    s_add_u32 m0, s68, 20480
    s_mov_b32 s74, 20480
    buffer_load_dwordx4 v1, s[44:47], s74 offen offset:0 nt lds
    buffer_load_dwordx4 v2, s[44:47], s74 offen offset:1024 nt lds
    buffer_load_dwordx4 v3, s[44:47], s74 offen offset:2048 nt lds
    buffer_load_dwordx4 v4, s[44:47], s74 offen offset:3072 nt lds
    s_load_dword s4, s[30:31], 0
    s_waitcnt vmcnt(16)
    ds_read_b128 v[100:103], v7 offset:0
    ds_read_b128 v[104:107], v8 offset:0
    ds_read_b128 v[108:111], v9 offset:0
    ds_read_b128 v[112:115], v10 offset:0
    ds_read_b128 v[116:119], v7 offset:4096
    ds_read_b128 v[120:123], v8 offset:4096
    ds_read_b128 v[124:127], v9 offset:4096
    ds_read_b128 v[128:131], v10 offset:4096
    s_waitcnt lgkmcnt(0)
    s_add_u32 m0, s68, 0
    s_mov_b32 s74, 24576
    buffer_load_dwordx4 v1, s[44:47], s74 offen offset:0 nt lds
    buffer_load_dwordx4 v2, s[44:47], s74 offen offset:1024 nt lds
    buffer_load_dwordx4 v3, s[44:47], s74 offen offset:2048 nt lds
    buffer_load_dwordx4 v4, s[44:47], s74 offen offset:3072 nt lds
    s_add_u32 m0, s68, 4096
    s_mov_b32 s74, 28672
    buffer_load_dwordx4 v1, s[44:47], s74 offen offset:0 nt lds
    buffer_load_dwordx4 v2, s[44:47], s74 offen offset:1024 nt lds
    buffer_load_dwordx4 v3, s[44:47], s74 offen offset:2048 nt lds
    buffer_load_dwordx4 v4, s[44:47], s74 offen offset:3072 nt lds
    s_waitcnt vmcnt(16)
    ds_read_b128 v[140:143], v7 offset:8192
    ds_read_b128 v[144:147], v8 offset:8192
    ds_read_b128 v[148:151], v9 offset:8192
    ds_read_b128 v[152:155], v10 offset:8192
    ds_read_b128 v[156:159], v7 offset:12288
    ds_read_b128 v[160:163], v8 offset:12288
    ds_read_b128 v[164:167], v9 offset:12288
    ds_read_b128 v[168:171], v10 offset:12288
    s_waitcnt lgkmcnt(0)
    s_add_u32 m0, s68, 8192
    s_mov_b32 s74, 32768
    buffer_load_dwordx4 v1, s[44:47], s74 offen offset:0 nt lds
    buffer_load_dwordx4 v2, s[44:47], s74 offen offset:1024 nt lds
    buffer_load_dwordx4 v3, s[44:47], s74 offen offset:2048 nt lds
    buffer_load_dwordx4 v4, s[44:47], s74 offen offset:3072 nt lds
    s_add_u32 m0, s68, 12288
    s_mov_b32 s74, 36864
    buffer_load_dwordx4 v1, s[44:47], s74 offen offset:0 nt lds
    buffer_load_dwordx4 v2, s[44:47], s74 offen offset:1024 nt lds
    buffer_load_dwordx4 v3, s[44:47], s74 offen offset:2048 nt lds
    buffer_load_dwordx4 v4, s[44:47], s74 offen offset:3072 nt lds
    s_waitcnt vmcnt(16)
    ds_read_b128 v[180:183], v7 offset:16384
    ds_read_b128 v[184:187], v8 offset:16384
    ds_read_b128 v[188:191], v9 offset:16384
    ds_read_b128 v[192:195], v10 offset:16384
    ds_read_b128 v[196:199], v7 offset:20480
    ds_read_b128 v[200:203], v8 offset:20480
    ds_read_b128 v[204:207], v9 offset:20480
    ds_read_b128 v[208:211], v10 offset:20480
    s_waitcnt lgkmcnt(0)
    s_add_u32 m0, s68, 16384
    s_mov_b32 s74, 40960
    buffer_load_dwordx4 v1, s[44:47], s74 offen offset:0 nt lds
    buffer_load_dwordx4 v2, s[44:47], s74 offen offset:1024 nt lds
    buffer_load_dwordx4 v3, s[44:47], s74 offen offset:2048 nt lds
    buffer_load_dwordx4 v4, s[44:47], s74 offen offset:3072 nt lds
    s_add_u32 m0, s68, 20480
    s_mov_b32 s74, 45056
    buffer_load_dwordx4 v1, s[44:47], s74 offen offset:0 nt lds
    buffer_load_dwordx4 v2, s[44:47], s74 offen offset:1024 nt lds
    buffer_load_dwordx4 v3, s[44:47], s74 offen offset:2048 nt lds
    buffer_load_dwordx4 v4, s[44:47], s74 offen offset:3072 nt lds
    s_waitcnt vmcnt(16)
    ds_read_b128 v[212:215], v7 offset:0
    ds_read_b128 v[216:219], v8 offset:0
    ds_read_b128 v[220:223], v9 offset:0
    ds_read_b128 v[224:227], v10 offset:0
    ds_read_b128 v[228:231], v7 offset:4096
    ds_read_b128 v[232:235], v8 offset:4096
    ds_read_b128 v[236:239], v9 offset:4096
    ds_read_b128 v[240:243], v10 offset:4096
    s_waitcnt lgkmcnt(0)
    s_add_u32 m0, s68, 0
    s_mov_b32 s74, 49152
    buffer_load_dwordx4 v1, s[44:47], s74 offen offset:0 nt lds
    buffer_load_dwordx4 v2, s[44:47], s74 offen offset:1024 nt lds
    buffer_load_dwordx4 v3, s[44:47], s74 offen offset:2048 nt lds
    buffer_load_dwordx4 v4, s[44:47], s74 offen offset:3072 nt lds
    s_add_u32 m0, s68, 4096
    s_mov_b32 s74, 53248
    buffer_load_dwordx4 v1, s[44:47], s74 offen offset:0 nt lds
    buffer_load_dwordx4 v2, s[44:47], s74 offen offset:1024 nt lds
    buffer_load_dwordx4 v3, s[44:47], s74 offen offset:2048 nt lds
    buffer_load_dwordx4 v4, s[44:47], s74 offen offset:3072 nt lds
    s_waitcnt vmcnt(16)
    ds_read_b128 v[36:39], v7 offset:8192
    ds_read_b128 v[40:43], v8 offset:8192
    ds_read_b128 v[44:47], v9 offset:8192
    ds_read_b128 v[48:51], v10 offset:8192
    ds_read_b128 v[52:55], v7 offset:12288
    ds_read_b128 v[56:59], v8 offset:12288
    ds_read_b128 v[60:63], v9 offset:12288
    ds_read_b128 v[64:67], v10 offset:12288
    s_waitcnt lgkmcnt(0)
    s_add_u32 m0, s68, 8192
    s_mov_b32 s74, 57344
    buffer_load_dwordx4 v1, s[44:47], s74 offen offset:0 nt lds
    buffer_load_dwordx4 v2, s[44:47], s74 offen offset:1024 nt lds
    buffer_load_dwordx4 v3, s[44:47], s74 offen offset:2048 nt lds
    buffer_load_dwordx4 v4, s[44:47], s74 offen offset:3072 nt lds
    s_add_u32 m0, s68, 12288
    s_mov_b32 s74, 61440
    buffer_load_dwordx4 v1, s[44:47], s74 offen offset:0 nt lds
    buffer_load_dwordx4 v2, s[44:47], s74 offen offset:1024 nt lds
    buffer_load_dwordx4 v3, s[44:47], s74 offen offset:2048 nt lds
    buffer_load_dwordx4 v4, s[44:47], s74 offen offset:3072 nt lds
    s_waitcnt lgkmcnt(0)
    s_add_u32 s16, s4, 1
    s_and_b32 s16, s16, 0xff
    s_add_u32 s17, s4, 65
    s_and_b32 s17, s17, 0xff
    s_add_u32 s18, s4, 129
    s_and_b32 s18, s18, 0xff
    s_add_u32 s19, s4, 193
    s_and_b32 s19, s19, 0xff
    v_and_b32 v174, 15, v0
    v_lshlrev_b32 v244, 9, v174
    v_lshrrev_b32 v176, 4, v0
    v_lshlrev_b32 v176, 4, v176
    v_add_u32 v244, v244, v176
    v_add_u32 v244, s68, v244
    v_lshlrev_b32 v245, 3, v0
    v_add_u32 v245, s68, v245
    v_and_b32 v246, 31, v0
    v_lshlrev_b32 v246, 4, v246
    s_lshl_b32 s66, s3, 9
    v_add_u32 v246, s66, v246
    v_add_u32 v247, 49152, v246
    s_lshl_b32 s67, s3, 3
    v_mov_b32 v248, s67
    v_add_u32 v249, 49152, v248
    s_lshl_b32 s66, s37, 4
    s_add_u32 s66, s66, s36
    s_lshl_b32 s66, s66, 2
    s_add_u32 s66, s66, s3
    s_lshl_b32 s66, s66, 10
    s_add_u32 s66, s66, 1048576
    v_lshlrev_b32 v250, 4, v0
    v_add_u32 v250, s66, v250
    v_and_b32 v251, 3, v0
    v_lshlrev_b32 v251, 8, v251
    v_add_u32 v251, v251, v176
    v_add_u32 v251, 98304, v251
    v_mov_b32 v252, s16
    v_mov_b32 v253, s17
    v_mov_b32 v254, s18
    v_mov_b32 v255, s19
    s_barrier
    ds_read_b128 v[20:23], v251 offset:0
    ds_read_b128 v[24:27], v251 offset:64
    ds_read_b128 v[28:31], v251 offset:128
    ds_read_b128 v[32:35], v251 offset:192
    s_waitcnt lgkmcnt(0)
    v_mfma_f32_16x16x32_bf16 v[68:71], v[100:103], v[20:23], 0
    v_mfma_f32_16x16x32_bf16 v[72:75], v[116:119], v[20:23], 0
    v_mfma_f32_16x16x32_bf16 v[68:71], v[104:107], v[24:27], v[68:71]
    v_mfma_f32_16x16x32_bf16 v[72:75], v[120:123], v[24:27], v[72:75]
    v_mfma_f32_16x16x32_bf16 v[68:71], v[108:111], v[28:31], v[68:71]
    v_mfma_f32_16x16x32_bf16 v[72:75], v[124:127], v[28:31], v[72:75]
    v_mfma_f32_16x16x32_bf16 v[68:71], v[112:115], v[32:35], v[68:71]
    v_mfma_f32_16x16x32_bf16 v[72:75], v[128:131], v[32:35], v[72:75]
    v_mfma_f32_16x16x32_bf16 v[76:79], v[140:143], v[20:23], 0
    v_mfma_f32_16x16x32_bf16 v[80:83], v[156:159], v[20:23], 0
    v_mfma_f32_16x16x32_bf16 v[76:79], v[144:147], v[24:27], v[76:79]
    v_mfma_f32_16x16x32_bf16 v[80:83], v[160:163], v[24:27], v[80:83]
    v_mfma_f32_16x16x32_bf16 v[76:79], v[148:151], v[28:31], v[76:79]
    v_mfma_f32_16x16x32_bf16 v[80:83], v[164:167], v[28:31], v[80:83]
    v_mfma_f32_16x16x32_bf16 v[76:79], v[152:155], v[32:35], v[76:79]
    v_mfma_f32_16x16x32_bf16 v[80:83], v[168:171], v[32:35], v[80:83]
    v_mfma_f32_16x16x32_bf16 v[84:87], v[180:183], v[20:23], 0
    v_mfma_f32_16x16x32_bf16 v[88:91], v[196:199], v[20:23], 0
    v_mfma_f32_16x16x32_bf16 v[84:87], v[184:187], v[24:27], v[84:87]
    v_mfma_f32_16x16x32_bf16 v[88:91], v[200:203], v[24:27], v[88:91]
    v_mfma_f32_16x16x32_bf16 v[84:87], v[188:191], v[28:31], v[84:87]
    v_mfma_f32_16x16x32_bf16 v[88:91], v[204:207], v[28:31], v[88:91]
    v_mfma_f32_16x16x32_bf16 v[84:87], v[192:195], v[32:35], v[84:87]
    v_mfma_f32_16x16x32_bf16 v[88:91], v[208:211], v[32:35], v[88:91]
    v_mfma_f32_16x16x32_bf16 v[92:95], v[212:215], v[20:23], 0
    v_mfma_f32_16x16x32_bf16 v[96:99], v[228:231], v[20:23], 0
    v_mfma_f32_16x16x32_bf16 v[92:95], v[216:219], v[24:27], v[92:95]
    v_mfma_f32_16x16x32_bf16 v[96:99], v[232:235], v[24:27], v[96:99]
    v_mfma_f32_16x16x32_bf16 v[92:95], v[220:223], v[28:31], v[92:95]
    v_mfma_f32_16x16x32_bf16 v[96:99], v[236:239], v[28:31], v[96:99]
    v_mfma_f32_16x16x32_bf16 v[92:95], v[224:227], v[32:35], v[92:95]
    v_mfma_f32_16x16x32_bf16 v[96:99], v[240:243], v[32:35], v[96:99]
    v_mfma_f32_16x16x32_bf16 v[100:103], v[36:39], v[20:23], 0
    v_mfma_f32_16x16x32_bf16 v[104:107], v[52:55], v[20:23], 0
    v_mfma_f32_16x16x32_bf16 v[100:103], v[40:43], v[24:27], v[100:103]
    v_mfma_f32_16x16x32_bf16 v[104:107], v[56:59], v[24:27], v[104:107]
    v_mfma_f32_16x16x32_bf16 v[100:103], v[44:47], v[28:31], v[100:103]
    v_mfma_f32_16x16x32_bf16 v[104:107], v[60:63], v[28:31], v[104:107]
    v_mfma_f32_16x16x32_bf16 v[100:103], v[48:51], v[32:35], v[100:103]
    v_mfma_f32_16x16x32_bf16 v[104:107], v[64:67], v[32:35], v[104:107]
    s_waitcnt vmcnt(16)
    ds_read_b128 v[36:39], v7 offset:16384
    ds_read_b128 v[40:43], v8 offset:16384
    ds_read_b128 v[44:47], v9 offset:16384
    ds_read_b128 v[48:51], v10 offset:16384
    ds_read_b128 v[52:55], v7 offset:20480
    ds_read_b128 v[56:59], v8 offset:20480
    ds_read_b128 v[60:63], v9 offset:20480
    ds_read_b128 v[64:67], v10 offset:20480
    s_waitcnt lgkmcnt(0)
    s_add_u32 m0, s68, 16384
    s_mov_b32 s74, 0
    buffer_load_dwordx4 v5, s[48:51], s74 offen offset:0 nt lds
    buffer_load_dwordx4 v6, s[48:51], s74 offen offset:1024 nt lds
    buffer_load_dwordx4 v5, s[48:51], s74 offen offset:2048 nt lds
    buffer_load_dwordx4 v6, s[48:51], s74 offen offset:3072 nt lds
    s_add_u32 m0, s68, 20480
    s_mov_b32 s74, 4096
    buffer_load_dwordx4 v5, s[48:51], s74 offen offset:0 nt lds
    buffer_load_dwordx4 v6, s[48:51], s74 offen offset:1024 nt lds
    buffer_load_dwordx4 v5, s[48:51], s74 offen offset:2048 nt lds
    buffer_load_dwordx4 v6, s[48:51], s74 offen offset:3072 nt lds
    v_mfma_f32_16x16x32_bf16 v[108:111], v[36:39], v[20:23], 0
    v_mfma_f32_16x16x32_bf16 v[112:115], v[52:55], v[20:23], 0
    v_mfma_f32_16x16x32_bf16 v[108:111], v[40:43], v[24:27], v[108:111]
    v_mfma_f32_16x16x32_bf16 v[112:115], v[56:59], v[24:27], v[112:115]
    v_mfma_f32_16x16x32_bf16 v[108:111], v[44:47], v[28:31], v[108:111]
    v_mfma_f32_16x16x32_bf16 v[112:115], v[60:63], v[28:31], v[112:115]
    v_mfma_f32_16x16x32_bf16 v[108:111], v[48:51], v[32:35], v[108:111]
    v_mfma_f32_16x16x32_bf16 v[112:115], v[64:67], v[32:35], v[112:115]
    s_waitcnt vmcnt(16)
    ds_read_b128 v[36:39], v7 offset:0
    ds_read_b128 v[40:43], v8 offset:0
    ds_read_b128 v[44:47], v9 offset:0
    ds_read_b128 v[48:51], v10 offset:0
    ds_read_b128 v[52:55], v7 offset:4096
    ds_read_b128 v[56:59], v8 offset:4096
    ds_read_b128 v[60:63], v9 offset:4096
    ds_read_b128 v[64:67], v10 offset:4096
    s_waitcnt lgkmcnt(0)
    s_add_u32 m0, s68, 0
    s_mov_b32 s74, 8192
    buffer_load_dwordx4 v5, s[48:51], s74 offen offset:0 nt lds
    buffer_load_dwordx4 v6, s[48:51], s74 offen offset:1024 nt lds
    buffer_load_dwordx4 v5, s[48:51], s74 offen offset:2048 nt lds
    buffer_load_dwordx4 v6, s[48:51], s74 offen offset:3072 nt lds
    s_add_u32 m0, s68, 4096
    s_mov_b32 s74, 12288
    buffer_load_dwordx4 v5, s[48:51], s74 offen offset:0 nt lds
    buffer_load_dwordx4 v6, s[48:51], s74 offen offset:1024 nt lds
    buffer_load_dwordx4 v5, s[48:51], s74 offen offset:2048 nt lds
    buffer_load_dwordx4 v6, s[48:51], s74 offen offset:3072 nt lds
    v_mfma_f32_16x16x32_bf16 v[116:119], v[36:39], v[20:23], 0
    v_mfma_f32_16x16x32_bf16 v[120:123], v[52:55], v[20:23], 0
    v_mfma_f32_16x16x32_bf16 v[116:119], v[40:43], v[24:27], v[116:119]
    v_mfma_f32_16x16x32_bf16 v[120:123], v[56:59], v[24:27], v[120:123]
    v_mfma_f32_16x16x32_bf16 v[116:119], v[44:47], v[28:31], v[116:119]
    v_mfma_f32_16x16x32_bf16 v[120:123], v[60:63], v[28:31], v[120:123]
    v_mfma_f32_16x16x32_bf16 v[116:119], v[48:51], v[32:35], v[116:119]
    v_mfma_f32_16x16x32_bf16 v[120:123], v[64:67], v[32:35], v[120:123]
    s_waitcnt vmcnt(16)
    ds_read_b128 v[36:39], v7 offset:8192
    ds_read_b128 v[40:43], v8 offset:8192
    ds_read_b128 v[44:47], v9 offset:8192
    ds_read_b128 v[48:51], v10 offset:8192
    ds_read_b128 v[52:55], v7 offset:12288
    ds_read_b128 v[56:59], v8 offset:12288
    ds_read_b128 v[60:63], v9 offset:12288
    ds_read_b128 v[64:67], v10 offset:12288
    s_waitcnt lgkmcnt(0)
    s_add_u32 m0, s68, 8192
    s_mov_b32 s74, 16384
    buffer_load_dwordx4 v5, s[48:51], s74 offen offset:0 nt lds
    buffer_load_dwordx4 v6, s[48:51], s74 offen offset:1024 nt lds
    buffer_load_dwordx4 v5, s[48:51], s74 offen offset:2048 nt lds
    buffer_load_dwordx4 v6, s[48:51], s74 offen offset:3072 nt lds
    s_add_u32 m0, s68, 12288
    s_mov_b32 s74, 20480
    buffer_load_dwordx4 v5, s[48:51], s74 offen offset:0 nt lds
    buffer_load_dwordx4 v6, s[48:51], s74 offen offset:1024 nt lds
    buffer_load_dwordx4 v5, s[48:51], s74 offen offset:2048 nt lds
    buffer_load_dwordx4 v6, s[48:51], s74 offen offset:3072 nt lds
    v_mfma_f32_16x16x32_bf16 v[124:127], v[36:39], v[20:23], 0
    v_mfma_f32_16x16x32_bf16 v[128:131], v[52:55], v[20:23], 0
    v_mfma_f32_16x16x32_bf16 v[124:127], v[40:43], v[24:27], v[124:127]
    v_mfma_f32_16x16x32_bf16 v[128:131], v[56:59], v[24:27], v[128:131]
    v_mfma_f32_16x16x32_bf16 v[124:127], v[44:47], v[28:31], v[124:127]
    v_mfma_f32_16x16x32_bf16 v[128:131], v[60:63], v[28:31], v[128:131]
    v_mfma_f32_16x16x32_bf16 v[124:127], v[48:51], v[32:35], v[124:127]
    v_mfma_f32_16x16x32_bf16 v[128:131], v[64:67], v[32:35], v[128:131]
    s_nop 7
    v_max3_f32 v172, v68, v69, v70
    v_max3_f32 v174, v71, v72, v73
    v_max3_f32 v172, v172, v74, v75
    v_max3_f32 v174, v174, v76, v77
    v_max3_f32 v172, v172, v78, v79
    v_max3_f32 v174, v174, v80, v81
    v_max3_f32 v172, v172, v82, v83
    v_max3_f32 v174, v174, v84, v85
    v_max3_f32 v172, v172, v86, v87
    v_max3_f32 v174, v174, v88, v89
    v_max3_f32 v172, v172, v90, v91
    v_max3_f32 v174, v174, v92, v93
    v_max3_f32 v172, v172, v94, v95
    v_max3_f32 v174, v174, v96, v97
    v_max3_f32 v172, v172, v98, v99
    v_max3_f32 v174, v174, v100, v101
    v_max3_f32 v172, v172, v102, v103
    v_max3_f32 v174, v174, v104, v105
    v_max3_f32 v172, v172, v106, v107
    v_max3_f32 v174, v174, v108, v109
    v_max3_f32 v172, v172, v110, v111
    v_max3_f32 v174, v174, v112, v113
    v_max3_f32 v172, v172, v114, v115
    v_max3_f32 v174, v174, v116, v117
    v_max3_f32 v172, v172, v118, v119
    v_max3_f32 v174, v174, v120, v121
    v_max3_f32 v172, v172, v122, v123
    v_max3_f32 v174, v174, v124, v125
    v_max3_f32 v172, v172, v126, v127
    v_max3_f32 v174, v174, v128, v129
    v_max3_f32 v172, v172, v130, v131
    v_max_f32 v172, v172, v174
    v_mov_b32 v174, v172
    s_nop 1
    v_permlane16_swap_b32 v172, v174
    s_nop 1
    v_max_f32 v172, v172, v174
    v_mov_b32 v174, v172
    s_nop 1
    v_permlane32_swap_b32 v172, v174
    s_nop 1
    v_max_f32 v172, v172, v174
    v_mul_f32 v175, s65, v172
    v_mov_b32 v173, 0
    v_mov_b32 v176, 0
    v_fma_f32 v68, v68, s64, v175
    v_fma_f32 v69, v69, s64, v175
    v_fma_f32 v70, v70, s64, v175
    v_fma_f32 v71, v71, s64, v175
    v_fma_f32 v72, v72, s64, v175
    v_fma_f32 v73, v73, s64, v175
    v_fma_f32 v74, v74, s64, v175
    v_fma_f32 v75, v75, s64, v175
    v_fma_f32 v76, v76, s64, v175
    v_fma_f32 v77, v77, s64, v175
    v_fma_f32 v78, v78, s64, v175
    v_fma_f32 v79, v79, s64, v175
    v_fma_f32 v80, v80, s64, v175
    v_fma_f32 v81, v81, s64, v175
    v_fma_f32 v82, v82, s64, v175
    v_fma_f32 v83, v83, s64, v175
    v_fma_f32 v84, v84, s64, v175
    v_fma_f32 v85, v85, s64, v175
    v_fma_f32 v86, v86, s64, v175
    v_fma_f32 v87, v87, s64, v175
    v_fma_f32 v88, v88, s64, v175
    v_fma_f32 v89, v89, s64, v175
    v_fma_f32 v90, v90, s64, v175
    v_fma_f32 v91, v91, s64, v175
    v_fma_f32 v92, v92, s64, v175
    v_fma_f32 v93, v93, s64, v175
    v_fma_f32 v94, v94, s64, v175
    v_fma_f32 v95, v95, s64, v175
    v_fma_f32 v96, v96, s64, v175
    v_fma_f32 v97, v97, s64, v175
    v_fma_f32 v98, v98, s64, v175
    v_fma_f32 v99, v99, s64, v175
    v_fma_f32 v100, v100, s64, v175
    v_fma_f32 v101, v101, s64, v175
    v_fma_f32 v102, v102, s64, v175
    v_fma_f32 v103, v103, s64, v175
    v_fma_f32 v104, v104, s64, v175
    v_fma_f32 v105, v105, s64, v175
    v_fma_f32 v106, v106, s64, v175
    v_fma_f32 v107, v107, s64, v175
    v_fma_f32 v108, v108, s64, v175
    v_fma_f32 v109, v109, s64, v175
    v_fma_f32 v110, v110, s64, v175
    v_fma_f32 v111, v111, s64, v175
    v_fma_f32 v112, v112, s64, v175
    v_fma_f32 v113, v113, s64, v175
    v_fma_f32 v114, v114, s64, v175
    v_fma_f32 v115, v115, s64, v175
    v_fma_f32 v116, v116, s64, v175
    v_fma_f32 v117, v117, s64, v175
    v_fma_f32 v118, v118, s64, v175
    v_fma_f32 v119, v119, s64, v175
    v_fma_f32 v120, v120, s64, v175
    v_fma_f32 v121, v121, s64, v175
    v_fma_f32 v122, v122, s64, v175
    v_fma_f32 v123, v123, s64, v175
    v_fma_f32 v124, v124, s64, v175
    v_fma_f32 v125, v125, s64, v175
    v_fma_f32 v126, v126, s64, v175
    v_fma_f32 v127, v127, s64, v175
    v_fma_f32 v128, v128, s64, v175
    v_fma_f32 v129, v129, s64, v175
    v_fma_f32 v130, v130, s64, v175
    v_fma_f32 v131, v131, s64, v175
    v_exp_f32 v68, v68
    v_exp_f32 v69, v69
    v_exp_f32 v70, v70
    v_exp_f32 v71, v71
    v_exp_f32 v72, v72
    v_exp_f32 v73, v73
    v_exp_f32 v74, v74
    v_exp_f32 v75, v75
    v_exp_f32 v76, v76
    v_exp_f32 v77, v77
    v_exp_f32 v78, v78
    v_exp_f32 v79, v79
    v_exp_f32 v80, v80
    v_exp_f32 v81, v81
    v_exp_f32 v82, v82
    v_exp_f32 v83, v83
    v_exp_f32 v84, v84
    v_exp_f32 v85, v85
    v_exp_f32 v86, v86
    v_exp_f32 v87, v87
    v_exp_f32 v88, v88
    v_exp_f32 v89, v89
    v_exp_f32 v90, v90
    v_exp_f32 v91, v91
    v_exp_f32 v92, v92
    v_exp_f32 v93, v93
    v_exp_f32 v94, v94
    v_exp_f32 v95, v95
    v_exp_f32 v96, v96
    v_exp_f32 v97, v97
    v_exp_f32 v98, v98
    v_exp_f32 v99, v99
    v_exp_f32 v100, v100
    v_exp_f32 v101, v101
    v_exp_f32 v102, v102
    v_exp_f32 v103, v103
    v_exp_f32 v104, v104
    v_exp_f32 v105, v105
    v_exp_f32 v106, v106
    v_exp_f32 v107, v107
    v_exp_f32 v108, v108
    v_exp_f32 v109, v109
    v_exp_f32 v110, v110
    v_exp_f32 v111, v111
    v_exp_f32 v112, v112
    v_exp_f32 v113, v113
    v_exp_f32 v114, v114
    v_exp_f32 v115, v115
    v_exp_f32 v116, v116
    v_exp_f32 v117, v117
    v_exp_f32 v118, v118
    v_exp_f32 v119, v119
    v_exp_f32 v120, v120
    v_exp_f32 v121, v121
    v_exp_f32 v122, v122
    v_exp_f32 v123, v123
    v_exp_f32 v124, v124
    v_exp_f32 v125, v125
    v_exp_f32 v126, v126
    v_exp_f32 v127, v127
    v_exp_f32 v128, v128
    v_exp_f32 v129, v129
    v_exp_f32 v130, v130
    v_exp_f32 v131, v131
    v_add_f32 v173, v173, v68
    v_add_f32 v176, v176, v69
    v_add_f32 v173, v173, v70
    v_add_f32 v176, v176, v71
    v_add_f32 v173, v173, v72
    v_add_f32 v176, v176, v73
    v_add_f32 v173, v173, v74
    v_add_f32 v176, v176, v75
    v_add_f32 v173, v173, v76
    v_add_f32 v176, v176, v77
    v_add_f32 v173, v173, v78
    v_add_f32 v176, v176, v79
    v_add_f32 v173, v173, v80
    v_add_f32 v176, v176, v81
    v_add_f32 v173, v173, v82
    v_add_f32 v176, v176, v83
    v_add_f32 v173, v173, v84
    v_add_f32 v176, v176, v85
    v_add_f32 v173, v173, v86
    v_add_f32 v176, v176, v87
    v_add_f32 v173, v173, v88
    v_add_f32 v176, v176, v89
    v_add_f32 v173, v173, v90
    v_add_f32 v176, v176, v91
    v_add_f32 v173, v173, v92
    v_add_f32 v176, v176, v93
    v_add_f32 v173, v173, v94
    v_add_f32 v176, v176, v95
    v_add_f32 v173, v173, v96
    v_add_f32 v176, v176, v97
    v_add_f32 v173, v173, v98
    v_add_f32 v176, v176, v99
    v_add_f32 v173, v173, v100
    v_add_f32 v176, v176, v101
    v_add_f32 v173, v173, v102
    v_add_f32 v176, v176, v103
    v_add_f32 v173, v173, v104
    v_add_f32 v176, v176, v105
    v_add_f32 v173, v173, v106
    v_add_f32 v176, v176, v107
    v_add_f32 v173, v173, v108
    v_add_f32 v176, v176, v109
    v_add_f32 v173, v173, v110
    v_add_f32 v176, v176, v111
    v_add_f32 v173, v173, v112
    v_add_f32 v176, v176, v113
    v_add_f32 v173, v173, v114
    v_add_f32 v176, v176, v115
    v_add_f32 v173, v173, v116
    v_add_f32 v176, v176, v117
    v_add_f32 v173, v173, v118
    v_add_f32 v176, v176, v119
    v_add_f32 v173, v173, v120
    v_add_f32 v176, v176, v121
    v_add_f32 v173, v173, v122
    v_add_f32 v176, v176, v123
    v_add_f32 v173, v173, v124
    v_add_f32 v176, v176, v125
    v_add_f32 v173, v173, v126
    v_add_f32 v176, v176, v127
    v_add_f32 v173, v173, v128
    v_add_f32 v176, v176, v129
    v_add_f32 v173, v173, v130
    v_add_f32 v176, v176, v131
    v_cvt_pk_bf16_f32 v68, v68, v69
    v_cvt_pk_bf16_f32 v69, v70, v71
    v_cvt_pk_bf16_f32 v70, v72, v73
    v_cvt_pk_bf16_f32 v71, v74, v75
    v_cvt_pk_bf16_f32 v72, v76, v77
    v_cvt_pk_bf16_f32 v73, v78, v79
    v_cvt_pk_bf16_f32 v74, v80, v81
    v_cvt_pk_bf16_f32 v75, v82, v83
    v_cvt_pk_bf16_f32 v76, v84, v85
    v_cvt_pk_bf16_f32 v77, v86, v87
    v_cvt_pk_bf16_f32 v78, v88, v89
    v_cvt_pk_bf16_f32 v79, v90, v91
    v_cvt_pk_bf16_f32 v80, v92, v93
    v_cvt_pk_bf16_f32 v81, v94, v95
    v_cvt_pk_bf16_f32 v82, v96, v97
    v_cvt_pk_bf16_f32 v83, v98, v99
    v_cvt_pk_bf16_f32 v84, v100, v101
    v_cvt_pk_bf16_f32 v85, v102, v103
    v_cvt_pk_bf16_f32 v86, v104, v105
    v_cvt_pk_bf16_f32 v87, v106, v107
    v_cvt_pk_bf16_f32 v88, v108, v109
    v_cvt_pk_bf16_f32 v89, v110, v111
    v_cvt_pk_bf16_f32 v90, v112, v113
    v_cvt_pk_bf16_f32 v91, v114, v115
    v_cvt_pk_bf16_f32 v92, v116, v117
    v_cvt_pk_bf16_f32 v93, v118, v119
    v_cvt_pk_bf16_f32 v94, v120, v121
    v_cvt_pk_bf16_f32 v95, v122, v123
    v_cvt_pk_bf16_f32 v96, v124, v125
    v_cvt_pk_bf16_f32 v97, v126, v127
    v_cvt_pk_bf16_f32 v98, v128, v129
    v_cvt_pk_bf16_f32 v99, v130, v131
    v_add_f32 v173, v173, v176
    v_mov_b32 v174, v173
    s_nop 1
    v_permlane16_swap_b32 v173, v174
    s_nop 1
    v_add_f32 v173, v173, v174
    v_mov_b32 v174, v173
    s_nop 1
    v_permlane32_swap_b32 v173, v174
    s_nop 1
    v_add_f32 v173, v173, v174
    s_waitcnt vmcnt(16)
    ds_read_b64_tr_b16 v[36:37], v11 offset:16384
    ds_read_b64_tr_b16 v[38:39], v11 offset:20480
    ds_read_b64_tr_b16 v[40:41], v12 offset:16384
    ds_read_b64_tr_b16 v[42:43], v12 offset:20480
    ds_read_b64_tr_b16 v[44:45], v13 offset:16384
    ds_read_b64_tr_b16 v[46:47], v13 offset:20480
    ds_read_b64_tr_b16 v[48:49], v14 offset:16384
    ds_read_b64_tr_b16 v[50:51], v14 offset:20480
    ds_read_b64_tr_b16 v[52:53], v15 offset:16384
    ds_read_b64_tr_b16 v[54:55], v15 offset:20480
    ds_read_b64_tr_b16 v[56:57], v16 offset:16384
    ds_read_b64_tr_b16 v[58:59], v16 offset:20480
    ds_read_b64_tr_b16 v[60:61], v17 offset:16384
    ds_read_b64_tr_b16 v[62:63], v17 offset:20480
    ds_read_b64_tr_b16 v[64:65], v18 offset:16384
    ds_read_b64_tr_b16 v[66:67], v18 offset:20480
    s_waitcnt lgkmcnt(0)
    s_add_u32 m0, s68, 16384
    s_mov_b32 s74, 24576
    buffer_load_dwordx4 v5, s[48:51], s74 offen offset:0 nt lds
    buffer_load_dwordx4 v6, s[48:51], s74 offen offset:1024 nt lds
    buffer_load_dwordx4 v5, s[48:51], s74 offen offset:2048 nt lds
    buffer_load_dwordx4 v6, s[48:51], s74 offen offset:3072 nt lds
    s_add_u32 m0, s68, 20480
    s_mov_b32 s74, 28672
    buffer_load_dwordx4 v5, s[48:51], s74 offen offset:0 nt lds
    buffer_load_dwordx4 v6, s[48:51], s74 offen offset:1024 nt lds
    buffer_load_dwordx4 v5, s[48:51], s74 offen offset:2048 nt lds
    buffer_load_dwordx4 v6, s[48:51], s74 offen offset:3072 nt lds
    v_mfma_f32_16x16x32_bf16 v[140:143], v[36:39], v[68:71], 0
    v_mfma_f32_16x16x32_bf16 v[144:147], v[40:43], v[68:71], 0
    v_mfma_f32_16x16x32_bf16 v[148:151], v[44:47], v[68:71], 0
    v_mfma_f32_16x16x32_bf16 v[152:155], v[48:51], v[68:71], 0
    v_mfma_f32_16x16x32_bf16 v[156:159], v[52:55], v[68:71], 0
    v_mfma_f32_16x16x32_bf16 v[160:163], v[56:59], v[68:71], 0
    v_mfma_f32_16x16x32_bf16 v[164:167], v[60:63], v[68:71], 0
    v_mfma_f32_16x16x32_bf16 v[168:171], v[64:67], v[68:71], 0
    s_waitcnt vmcnt(16)
    ds_read_b64_tr_b16 v[36:37], v11 offset:0
    ds_read_b64_tr_b16 v[38:39], v11 offset:4096
    ds_read_b64_tr_b16 v[40:41], v12 offset:0
    ds_read_b64_tr_b16 v[42:43], v12 offset:4096
    ds_read_b64_tr_b16 v[44:45], v13 offset:0
    ds_read_b64_tr_b16 v[46:47], v13 offset:4096
    ds_read_b64_tr_b16 v[48:49], v14 offset:0
    ds_read_b64_tr_b16 v[50:51], v14 offset:4096
    ds_read_b64_tr_b16 v[52:53], v15 offset:0
    ds_read_b64_tr_b16 v[54:55], v15 offset:4096
    ds_read_b64_tr_b16 v[56:57], v16 offset:0
    ds_read_b64_tr_b16 v[58:59], v16 offset:4096
    ds_read_b64_tr_b16 v[60:61], v17 offset:0
    ds_read_b64_tr_b16 v[62:63], v17 offset:4096
    ds_read_b64_tr_b16 v[64:65], v18 offset:0
    ds_read_b64_tr_b16 v[66:67], v18 offset:4096
    s_waitcnt lgkmcnt(0)
    s_add_u32 m0, s68, 0
    s_mov_b32 s74, 32768
    buffer_load_dwordx4 v5, s[48:51], s74 offen offset:0 nt lds
    buffer_load_dwordx4 v6, s[48:51], s74 offen offset:1024 nt lds
    buffer_load_dwordx4 v5, s[48:51], s74 offen offset:2048 nt lds
    buffer_load_dwordx4 v6, s[48:51], s74 offen offset:3072 nt lds
    s_add_u32 m0, s68, 4096
    s_mov_b32 s74, 36864
    buffer_load_dwordx4 v5, s[48:51], s74 offen offset:0 nt lds
    buffer_load_dwordx4 v6, s[48:51], s74 offen offset:1024 nt lds
    buffer_load_dwordx4 v5, s[48:51], s74 offen offset:2048 nt lds
    buffer_load_dwordx4 v6, s[48:51], s74 offen offset:3072 nt lds
    v_mfma_f32_16x16x32_bf16 v[140:143], v[36:39], v[72:75], v[140:143]
    v_mfma_f32_16x16x32_bf16 v[144:147], v[40:43], v[72:75], v[144:147]
    v_mfma_f32_16x16x32_bf16 v[148:151], v[44:47], v[72:75], v[148:151]
    v_mfma_f32_16x16x32_bf16 v[152:155], v[48:51], v[72:75], v[152:155]
    v_mfma_f32_16x16x32_bf16 v[156:159], v[52:55], v[72:75], v[156:159]
    v_mfma_f32_16x16x32_bf16 v[160:163], v[56:59], v[72:75], v[160:163]
    v_mfma_f32_16x16x32_bf16 v[164:167], v[60:63], v[72:75], v[164:167]
    v_mfma_f32_16x16x32_bf16 v[168:171], v[64:67], v[72:75], v[168:171]
    s_waitcnt vmcnt(16)
    ds_read_b64_tr_b16 v[36:37], v11 offset:8192
    ds_read_b64_tr_b16 v[38:39], v11 offset:12288
    ds_read_b64_tr_b16 v[40:41], v12 offset:8192
    ds_read_b64_tr_b16 v[42:43], v12 offset:12288
    ds_read_b64_tr_b16 v[44:45], v13 offset:8192
    ds_read_b64_tr_b16 v[46:47], v13 offset:12288
    ds_read_b64_tr_b16 v[48:49], v14 offset:8192
    ds_read_b64_tr_b16 v[50:51], v14 offset:12288
    ds_read_b64_tr_b16 v[52:53], v15 offset:8192
    ds_read_b64_tr_b16 v[54:55], v15 offset:12288
    ds_read_b64_tr_b16 v[56:57], v16 offset:8192
    ds_read_b64_tr_b16 v[58:59], v16 offset:12288
    ds_read_b64_tr_b16 v[60:61], v17 offset:8192
    ds_read_b64_tr_b16 v[62:63], v17 offset:12288
    ds_read_b64_tr_b16 v[64:65], v18 offset:8192
    ds_read_b64_tr_b16 v[66:67], v18 offset:12288
    s_waitcnt lgkmcnt(0)
    s_add_u32 m0, s68, 8192
    s_mov_b32 s74, 40960
    buffer_load_dwordx4 v5, s[48:51], s74 offen offset:0 nt lds
    buffer_load_dwordx4 v6, s[48:51], s74 offen offset:1024 nt lds
    buffer_load_dwordx4 v5, s[48:51], s74 offen offset:2048 nt lds
    buffer_load_dwordx4 v6, s[48:51], s74 offen offset:3072 nt lds
    s_add_u32 m0, s68, 12288
    s_mov_b32 s74, 45056
    buffer_load_dwordx4 v5, s[48:51], s74 offen offset:0 nt lds
    buffer_load_dwordx4 v6, s[48:51], s74 offen offset:1024 nt lds
    buffer_load_dwordx4 v5, s[48:51], s74 offen offset:2048 nt lds
    buffer_load_dwordx4 v6, s[48:51], s74 offen offset:3072 nt lds
    v_mfma_f32_16x16x32_bf16 v[140:143], v[36:39], v[76:79], v[140:143]
    v_mfma_f32_16x16x32_bf16 v[144:147], v[40:43], v[76:79], v[144:147]
    v_mfma_f32_16x16x32_bf16 v[148:151], v[44:47], v[76:79], v[148:151]
    v_mfma_f32_16x16x32_bf16 v[152:155], v[48:51], v[76:79], v[152:155]
    v_mfma_f32_16x16x32_bf16 v[156:159], v[52:55], v[76:79], v[156:159]
    v_mfma_f32_16x16x32_bf16 v[160:163], v[56:59], v[76:79], v[160:163]
    v_mfma_f32_16x16x32_bf16 v[164:167], v[60:63], v[76:79], v[164:167]
    v_mfma_f32_16x16x32_bf16 v[168:171], v[64:67], v[76:79], v[168:171]
    s_waitcnt vmcnt(16)
    ds_read_b64_tr_b16 v[36:37], v11 offset:16384
    ds_read_b64_tr_b16 v[38:39], v11 offset:20480
    ds_read_b64_tr_b16 v[40:41], v12 offset:16384
    ds_read_b64_tr_b16 v[42:43], v12 offset:20480
    ds_read_b64_tr_b16 v[44:45], v13 offset:16384
    ds_read_b64_tr_b16 v[46:47], v13 offset:20480
    ds_read_b64_tr_b16 v[48:49], v14 offset:16384
    ds_read_b64_tr_b16 v[50:51], v14 offset:20480
    ds_read_b64_tr_b16 v[52:53], v15 offset:16384
    ds_read_b64_tr_b16 v[54:55], v15 offset:20480
    ds_read_b64_tr_b16 v[56:57], v16 offset:16384
    ds_read_b64_tr_b16 v[58:59], v16 offset:20480
    ds_read_b64_tr_b16 v[60:61], v17 offset:16384
    ds_read_b64_tr_b16 v[62:63], v17 offset:20480
    ds_read_b64_tr_b16 v[64:65], v18 offset:16384
    ds_read_b64_tr_b16 v[66:67], v18 offset:20480
    s_waitcnt lgkmcnt(0)
    s_add_u32 m0, s68, 16384
    s_mov_b32 s74, 49152
    buffer_load_dwordx4 v5, s[48:51], s74 offen offset:0 nt lds
    buffer_load_dwordx4 v6, s[48:51], s74 offen offset:1024 nt lds
    buffer_load_dwordx4 v5, s[48:51], s74 offen offset:2048 nt lds
    buffer_load_dwordx4 v6, s[48:51], s74 offen offset:3072 nt lds
    s_add_u32 m0, s68, 20480
    s_mov_b32 s74, 53248
    buffer_load_dwordx4 v5, s[48:51], s74 offen offset:0 nt lds
    buffer_load_dwordx4 v6, s[48:51], s74 offen offset:1024 nt lds
    buffer_load_dwordx4 v5, s[48:51], s74 offen offset:2048 nt lds
    buffer_load_dwordx4 v6, s[48:51], s74 offen offset:3072 nt lds
    v_mfma_f32_16x16x32_bf16 v[140:143], v[36:39], v[80:83], v[140:143]
    v_mfma_f32_16x16x32_bf16 v[144:147], v[40:43], v[80:83], v[144:147]
    v_mfma_f32_16x16x32_bf16 v[148:151], v[44:47], v[80:83], v[148:151]
    v_mfma_f32_16x16x32_bf16 v[152:155], v[48:51], v[80:83], v[152:155]
    v_mfma_f32_16x16x32_bf16 v[156:159], v[52:55], v[80:83], v[156:159]
    v_mfma_f32_16x16x32_bf16 v[160:163], v[56:59], v[80:83], v[160:163]
    v_mfma_f32_16x16x32_bf16 v[164:167], v[60:63], v[80:83], v[164:167]
    v_mfma_f32_16x16x32_bf16 v[168:171], v[64:67], v[80:83], v[168:171]
    s_waitcnt vmcnt(16)
    ds_read_b64_tr_b16 v[36:37], v11 offset:0
    ds_read_b64_tr_b16 v[38:39], v11 offset:4096
    ds_read_b64_tr_b16 v[40:41], v12 offset:0
    ds_read_b64_tr_b16 v[42:43], v12 offset:4096
    ds_read_b64_tr_b16 v[44:45], v13 offset:0
    ds_read_b64_tr_b16 v[46:47], v13 offset:4096
    ds_read_b64_tr_b16 v[48:49], v14 offset:0
    ds_read_b64_tr_b16 v[50:51], v14 offset:4096
    ds_read_b64_tr_b16 v[52:53], v15 offset:0
    ds_read_b64_tr_b16 v[54:55], v15 offset:4096
    ds_read_b64_tr_b16 v[56:57], v16 offset:0
    ds_read_b64_tr_b16 v[58:59], v16 offset:4096
    ds_read_b64_tr_b16 v[60:61], v17 offset:0
    ds_read_b64_tr_b16 v[62:63], v17 offset:4096
    ds_read_b64_tr_b16 v[64:65], v18 offset:0
    ds_read_b64_tr_b16 v[66:67], v18 offset:4096
    s_waitcnt lgkmcnt(0)
    s_add_u32 m0, s68, 0
    s_mov_b32 s74, 57344
    buffer_load_dwordx4 v5, s[48:51], s74 offen offset:0 nt lds
    buffer_load_dwordx4 v6, s[48:51], s74 offen offset:1024 nt lds
    buffer_load_dwordx4 v5, s[48:51], s74 offen offset:2048 nt lds
    buffer_load_dwordx4 v6, s[48:51], s74 offen offset:3072 nt lds
    s_add_u32 m0, s68, 4096
    s_mov_b32 s74, 61440
    buffer_load_dwordx4 v5, s[48:51], s74 offen offset:0 nt lds
    buffer_load_dwordx4 v6, s[48:51], s74 offen offset:1024 nt lds
    buffer_load_dwordx4 v5, s[48:51], s74 offen offset:2048 nt lds
    buffer_load_dwordx4 v6, s[48:51], s74 offen offset:3072 nt lds
    v_mfma_f32_16x16x32_bf16 v[140:143], v[36:39], v[84:87], v[140:143]
    v_mfma_f32_16x16x32_bf16 v[144:147], v[40:43], v[84:87], v[144:147]
    v_mfma_f32_16x16x32_bf16 v[148:151], v[44:47], v[84:87], v[148:151]
    v_mfma_f32_16x16x32_bf16 v[152:155], v[48:51], v[84:87], v[152:155]
    v_mfma_f32_16x16x32_bf16 v[156:159], v[52:55], v[84:87], v[156:159]
    v_mfma_f32_16x16x32_bf16 v[160:163], v[56:59], v[84:87], v[160:163]
    v_mfma_f32_16x16x32_bf16 v[164:167], v[60:63], v[84:87], v[164:167]
    v_mfma_f32_16x16x32_bf16 v[168:171], v[64:67], v[84:87], v[168:171]
    s_waitcnt vmcnt(16)
    ds_read_b64_tr_b16 v[36:37], v11 offset:8192
    ds_read_b64_tr_b16 v[38:39], v11 offset:12288
    ds_read_b64_tr_b16 v[40:41], v12 offset:8192
    ds_read_b64_tr_b16 v[42:43], v12 offset:12288
    ds_read_b64_tr_b16 v[44:45], v13 offset:8192
    ds_read_b64_tr_b16 v[46:47], v13 offset:12288
    ds_read_b64_tr_b16 v[48:49], v14 offset:8192
    ds_read_b64_tr_b16 v[50:51], v14 offset:12288
    ds_read_b64_tr_b16 v[52:53], v15 offset:8192
    ds_read_b64_tr_b16 v[54:55], v15 offset:12288
    ds_read_b64_tr_b16 v[56:57], v16 offset:8192
    ds_read_b64_tr_b16 v[58:59], v16 offset:12288
    ds_read_b64_tr_b16 v[60:61], v17 offset:8192
    ds_read_b64_tr_b16 v[62:63], v17 offset:12288
    ds_read_b64_tr_b16 v[64:65], v18 offset:8192
    ds_read_b64_tr_b16 v[66:67], v18 offset:12288
    s_waitcnt lgkmcnt(0)
    v_mfma_f32_16x16x32_bf16 v[140:143], v[36:39], v[88:91], v[140:143]
    v_mfma_f32_16x16x32_bf16 v[144:147], v[40:43], v[88:91], v[144:147]
    v_mfma_f32_16x16x32_bf16 v[148:151], v[44:47], v[88:91], v[148:151]
    v_mfma_f32_16x16x32_bf16 v[152:155], v[48:51], v[88:91], v[152:155]
    v_mfma_f32_16x16x32_bf16 v[156:159], v[52:55], v[88:91], v[156:159]
    v_mfma_f32_16x16x32_bf16 v[160:163], v[56:59], v[88:91], v[160:163]
    v_mfma_f32_16x16x32_bf16 v[164:167], v[60:63], v[88:91], v[164:167]
    v_mfma_f32_16x16x32_bf16 v[168:171], v[64:67], v[88:91], v[168:171]
    s_waitcnt vmcnt(8)
    ds_read_b64_tr_b16 v[36:37], v11 offset:16384
    ds_read_b64_tr_b16 v[38:39], v11 offset:20480
    ds_read_b64_tr_b16 v[40:41], v12 offset:16384
    ds_read_b64_tr_b16 v[42:43], v12 offset:20480
    ds_read_b64_tr_b16 v[44:45], v13 offset:16384
    ds_read_b64_tr_b16 v[46:47], v13 offset:20480
    ds_read_b64_tr_b16 v[48:49], v14 offset:16384
    ds_read_b64_tr_b16 v[50:51], v14 offset:20480
    ds_read_b64_tr_b16 v[52:53], v15 offset:16384
    ds_read_b64_tr_b16 v[54:55], v15 offset:20480
    ds_read_b64_tr_b16 v[56:57], v16 offset:16384
    ds_read_b64_tr_b16 v[58:59], v16 offset:20480
    ds_read_b64_tr_b16 v[60:61], v17 offset:16384
    ds_read_b64_tr_b16 v[62:63], v17 offset:20480
    ds_read_b64_tr_b16 v[64:65], v18 offset:16384
    ds_read_b64_tr_b16 v[66:67], v18 offset:20480
    s_waitcnt lgkmcnt(0)
    v_mfma_f32_16x16x32_bf16 v[140:143], v[36:39], v[92:95], v[140:143]
    v_mfma_f32_16x16x32_bf16 v[144:147], v[40:43], v[92:95], v[144:147]
    v_mfma_f32_16x16x32_bf16 v[148:151], v[44:47], v[92:95], v[148:151]
    v_mfma_f32_16x16x32_bf16 v[152:155], v[48:51], v[92:95], v[152:155]
    v_mfma_f32_16x16x32_bf16 v[156:159], v[52:55], v[92:95], v[156:159]
    v_mfma_f32_16x16x32_bf16 v[160:163], v[56:59], v[92:95], v[160:163]
    v_mfma_f32_16x16x32_bf16 v[164:167], v[60:63], v[92:95], v[164:167]
    v_mfma_f32_16x16x32_bf16 v[168:171], v[64:67], v[92:95], v[168:171]
    s_waitcnt vmcnt(0)
    ds_read_b64_tr_b16 v[36:37], v11 offset:0
    ds_read_b64_tr_b16 v[38:39], v11 offset:4096
    ds_read_b64_tr_b16 v[40:41], v12 offset:0
    ds_read_b64_tr_b16 v[42:43], v12 offset:4096
    ds_read_b64_tr_b16 v[44:45], v13 offset:0
    ds_read_b64_tr_b16 v[46:47], v13 offset:4096
    ds_read_b64_tr_b16 v[48:49], v14 offset:0
    ds_read_b64_tr_b16 v[50:51], v14 offset:4096
    ds_read_b64_tr_b16 v[52:53], v15 offset:0
    ds_read_b64_tr_b16 v[54:55], v15 offset:4096
    ds_read_b64_tr_b16 v[56:57], v16 offset:0
    ds_read_b64_tr_b16 v[58:59], v16 offset:4096
    ds_read_b64_tr_b16 v[60:61], v17 offset:0
    ds_read_b64_tr_b16 v[62:63], v17 offset:4096
    ds_read_b64_tr_b16 v[64:65], v18 offset:0
    ds_read_b64_tr_b16 v[66:67], v18 offset:4096
    s_waitcnt lgkmcnt(0)
    v_mfma_f32_16x16x32_bf16 v[140:143], v[36:39], v[96:99], v[140:143]
    v_mfma_f32_16x16x32_bf16 v[144:147], v[40:43], v[96:99], v[144:147]
    v_mfma_f32_16x16x32_bf16 v[148:151], v[44:47], v[96:99], v[148:151]
    v_mfma_f32_16x16x32_bf16 v[152:155], v[48:51], v[96:99], v[152:155]
    v_mfma_f32_16x16x32_bf16 v[156:159], v[52:55], v[96:99], v[156:159]
    v_mfma_f32_16x16x32_bf16 v[160:163], v[56:59], v[96:99], v[160:163]
    v_mfma_f32_16x16x32_bf16 v[164:167], v[60:63], v[96:99], v[164:167]
    v_mfma_f32_16x16x32_bf16 v[168:171], v[64:67], v[96:99], v[168:171]
    s_branch L_scommon
L_s9:
    s_add_u32 m0, s68, 0
    s_mov_b32 s74, 0
    buffer_load_dwordx4 v1, s[44:47], s74 offen offset:0 nt lds
    buffer_load_dwordx4 v2, s[44:47], s74 offen offset:1024 nt lds
    buffer_load_dwordx4 v3, s[44:47], s74 offen offset:2048 nt lds
    buffer_load_dwordx4 v4, s[44:47], s74 offen offset:3072 nt lds
    s_add_u32 m0, s68, 4096
    s_mov_b32 s74, 4096
    buffer_load_dwordx4 v1, s[44:47], s74 offen offset:0 nt lds
    buffer_load_dwordx4 v2, s[44:47], s74 offen offset:1024 nt lds
    buffer_load_dwordx4 v3, s[44:47], s74 offen offset:2048 nt lds
    buffer_load_dwordx4 v4, s[44:47], s74 offen offset:3072 nt lds
    s_add_u32 m0, s68, 8192
    s_mov_b32 s74, 8192
    buffer_load_dwordx4 v1, s[44:47], s74 offen offset:0 nt lds
    buffer_load_dwordx4 v2, s[44:47], s74 offen offset:1024 nt lds
    buffer_load_dwordx4 v3, s[44:47], s74 offen offset:2048 nt lds
    buffer_load_dwordx4 v4, s[44:47], s74 offen offset:3072 nt lds
    s_add_u32 m0, s68, 12288
    s_mov_b32 s74, 12288
    buffer_load_dwordx4 v1, s[44:47], s74 offen offset:0 nt lds
    buffer_load_dwordx4 v2, s[44:47], s74 offen offset:1024 nt lds
    buffer_load_dwordx4 v3, s[44:47], s74 offen offset:2048 nt lds
    buffer_load_dwordx4 v4, s[44:47], s74 offen offset:3072 nt lds
    s_add_u32 m0, s68, 16384
    s_mov_b32 s74, 16384
    buffer_load_dwordx4 v1, s[44:47], s74 offen offset:0 nt lds
    buffer_load_dwordx4 v2, s[44:47], s74 offen offset:1024 nt lds
    buffer_load_dwordx4 v3, s[44:47], s74 offen offset:2048 nt lds
    buffer_load_dwordx4 v4, s[44:47], s74 offen offset:3072 nt lds
    s_add_u32 m0, s68, 20480
    s_mov_b32 s74, 20480
    buffer_load_dwordx4 v1, s[44:47], s74 offen offset:0 nt lds
    buffer_load_dwordx4 v2, s[44:47], s74 offen offset:1024 nt lds
    buffer_load_dwordx4 v3, s[44:47], s74 offen offset:2048 nt lds
    buffer_load_dwordx4 v4, s[44:47], s74 offen offset:3072 nt lds
    s_load_dword s4, s[30:31], 0
    s_waitcnt vmcnt(16)
    ds_read_b128 v[100:103], v7 offset:0
    ds_read_b128 v[104:107], v8 offset:0
    ds_read_b128 v[108:111], v9 offset:0
    ds_read_b128 v[112:115], v10 offset:0
    ds_read_b128 v[116:119], v7 offset:4096
    ds_read_b128 v[120:123], v8 offset:4096
    ds_read_b128 v[124:127], v9 offset:4096
    ds_read_b128 v[128:131], v10 offset:4096
    s_waitcnt lgkmcnt(0)
    s_add_u32 m0, s68, 0
    s_mov_b32 s74, 24576
    buffer_load_dwordx4 v1, s[44:47], s74 offen offset:0 nt lds
    buffer_load_dwordx4 v2, s[44:47], s74 offen offset:1024 nt lds
    buffer_load_dwordx4 v3, s[44:47], s74 offen offset:2048 nt lds
    buffer_load_dwordx4 v4, s[44:47], s74 offen offset:3072 nt lds
    s_add_u32 m0, s68, 4096
    s_mov_b32 s74, 28672
    buffer_load_dwordx4 v1, s[44:47], s74 offen offset:0 nt lds
    buffer_load_dwordx4 v2, s[44:47], s74 offen offset:1024 nt lds
    buffer_load_dwordx4 v3, s[44:47], s74 offen offset:2048 nt lds
    buffer_load_dwordx4 v4, s[44:47], s74 offen offset:3072 nt lds
    s_waitcnt vmcnt(16)
    ds_read_b128 v[140:143], v7 offset:8192
    ds_read_b128 v[144:147], v8 offset:8192
    ds_read_b128 v[148:151], v9 offset:8192
    ds_read_b128 v[152:155], v10 offset:8192
    ds_read_b128 v[156:159], v7 offset:12288
    ds_read_b128 v[160:163], v8 offset:12288
    ds_read_b128 v[164:167], v9 offset:12288
    ds_read_b128 v[168:171], v10 offset:12288
    s_waitcnt lgkmcnt(0)
    s_add_u32 m0, s68, 8192
    s_mov_b32 s74, 32768
    buffer_load_dwordx4 v1, s[44:47], s74 offen offset:0 nt lds
    buffer_load_dwordx4 v2, s[44:47], s74 offen offset:1024 nt lds
    buffer_load_dwordx4 v3, s[44:47], s74 offen offset:2048 nt lds
    buffer_load_dwordx4 v4, s[44:47], s74 offen offset:3072 nt lds
    s_add_u32 m0, s68, 12288
    s_mov_b32 s74, 36864
    buffer_load_dwordx4 v1, s[44:47], s74 offen offset:0 nt lds
    buffer_load_dwordx4 v2, s[44:47], s74 offen offset:1024 nt lds
    buffer_load_dwordx4 v3, s[44:47], s74 offen offset:2048 nt lds
    buffer_load_dwordx4 v4, s[44:47], s74 offen offset:3072 nt lds
    s_waitcnt vmcnt(16)
    ds_read_b128 v[180:183], v7 offset:16384
    ds_read_b128 v[184:187], v8 offset:16384
    ds_read_b128 v[188:191], v9 offset:16384
    ds_read_b128 v[192:195], v10 offset:16384
    ds_read_b128 v[196:199], v7 offset:20480
    ds_read_b128 v[200:203], v8 offset:20480
    ds_read_b128 v[204:207], v9 offset:20480
    ds_read_b128 v[208:211], v10 offset:20480
    s_waitcnt lgkmcnt(0)
    s_add_u32 m0, s68, 16384
    s_mov_b32 s74, 40960
    buffer_load_dwordx4 v1, s[44:47], s74 offen offset:0 nt lds
    buffer_load_dwordx4 v2, s[44:47], s74 offen offset:1024 nt lds
    buffer_load_dwordx4 v3, s[44:47], s74 offen offset:2048 nt lds
    buffer_load_dwordx4 v4, s[44:47], s74 offen offset:3072 nt lds
    s_add_u32 m0, s68, 20480
    s_mov_b32 s74, 45056
    buffer_load_dwordx4 v1, s[44:47], s74 offen offset:0 nt lds
    buffer_load_dwordx4 v2, s[44:47], s74 offen offset:1024 nt lds
    buffer_load_dwordx4 v3, s[44:47], s74 offen offset:2048 nt lds
    buffer_load_dwordx4 v4, s[44:47], s74 offen offset:3072 nt lds
    s_waitcnt vmcnt(16)
    ds_read_b128 v[212:215], v7 offset:0
    ds_read_b128 v[216:219], v8 offset:0
    ds_read_b128 v[220:223], v9 offset:0
    ds_read_b128 v[224:227], v10 offset:0
    ds_read_b128 v[228:231], v7 offset:4096
    ds_read_b128 v[232:235], v8 offset:4096
    ds_read_b128 v[236:239], v9 offset:4096
    ds_read_b128 v[240:243], v10 offset:4096
    s_waitcnt lgkmcnt(0)
    s_add_u32 m0, s68, 0
    s_mov_b32 s74, 49152
    buffer_load_dwordx4 v1, s[44:47], s74 offen offset:0 nt lds
    buffer_load_dwordx4 v2, s[44:47], s74 offen offset:1024 nt lds
    buffer_load_dwordx4 v3, s[44:47], s74 offen offset:2048 nt lds
    buffer_load_dwordx4 v4, s[44:47], s74 offen offset:3072 nt lds
    s_add_u32 m0, s68, 4096
    s_mov_b32 s74, 53248
    buffer_load_dwordx4 v1, s[44:47], s74 offen offset:0 nt lds
    buffer_load_dwordx4 v2, s[44:47], s74 offen offset:1024 nt lds
    buffer_load_dwordx4 v3, s[44:47], s74 offen offset:2048 nt lds
    buffer_load_dwordx4 v4, s[44:47], s74 offen offset:3072 nt lds
    s_waitcnt vmcnt(16)
    ds_read_b128 v[36:39], v7 offset:8192
    ds_read_b128 v[40:43], v8 offset:8192
    ds_read_b128 v[44:47], v9 offset:8192
    ds_read_b128 v[48:51], v10 offset:8192
    ds_read_b128 v[52:55], v7 offset:12288
    ds_read_b128 v[56:59], v8 offset:12288
    ds_read_b128 v[60:63], v9 offset:12288
    ds_read_b128 v[64:67], v10 offset:12288
    s_waitcnt lgkmcnt(0)
    s_add_u32 m0, s68, 8192
    s_mov_b32 s74, 57344
    buffer_load_dwordx4 v1, s[44:47], s74 offen offset:0 nt lds
    buffer_load_dwordx4 v2, s[44:47], s74 offen offset:1024 nt lds
    buffer_load_dwordx4 v3, s[44:47], s74 offen offset:2048 nt lds
    buffer_load_dwordx4 v4, s[44:47], s74 offen offset:3072 nt lds
    s_add_u32 m0, s68, 12288
    s_mov_b32 s74, 61440
    buffer_load_dwordx4 v1, s[44:47], s74 offen offset:0 nt lds
    buffer_load_dwordx4 v2, s[44:47], s74 offen offset:1024 nt lds
    buffer_load_dwordx4 v3, s[44:47], s74 offen offset:2048 nt lds
    buffer_load_dwordx4 v4, s[44:47], s74 offen offset:3072 nt lds
    s_waitcnt lgkmcnt(0)
    s_add_u32 s16, s4, 1
    s_and_b32 s16, s16, 0xff
    s_add_u32 s17, s4, 65
    s_and_b32 s17, s17, 0xff
    s_add_u32 s18, s4, 129
    s_and_b32 s18, s18, 0xff
    s_add_u32 s19, s4, 193
    s_and_b32 s19, s19, 0xff
    v_and_b32 v174, 15, v0
    v_lshlrev_b32 v244, 9, v174
    v_lshrrev_b32 v176, 4, v0
    v_lshlrev_b32 v176, 4, v176
    v_add_u32 v244, v244, v176
    v_add_u32 v244, s68, v244
    v_lshlrev_b32 v245, 3, v0
    v_add_u32 v245, s68, v245
    v_and_b32 v246, 31, v0
    v_lshlrev_b32 v246, 4, v246
    s_lshl_b32 s66, s3, 9
    v_add_u32 v246, s66, v246
    v_add_u32 v247, 49152, v246
    s_lshl_b32 s67, s3, 3
    v_mov_b32 v248, s67
    v_add_u32 v249, 49152, v248
    s_lshl_b32 s66, s37, 4
    s_add_u32 s66, s66, s36
    s_lshl_b32 s66, s66, 2
    s_add_u32 s66, s66, s3
    s_lshl_b32 s66, s66, 10
    s_add_u32 s66, s66, 1048576
    v_lshlrev_b32 v250, 4, v0
    v_add_u32 v250, s66, v250
    v_and_b32 v251, 3, v0
    v_lshlrev_b32 v251, 8, v251
    v_add_u32 v251, v251, v176
    v_add_u32 v251, 98304, v251
    v_mov_b32 v252, s16
    v_mov_b32 v253, s17
    v_mov_b32 v254, s18
    v_mov_b32 v255, s19
    s_barrier
    ds_read_b128 v[20:23], v251 offset:0
    ds_read_b128 v[24:27], v251 offset:64
    ds_read_b128 v[28:31], v251 offset:128
    ds_read_b128 v[32:35], v251 offset:192
    s_waitcnt lgkmcnt(0)
    v_mfma_f32_16x16x32_bf16 v[68:71], v[100:103], v[20:23], 0
    v_mfma_f32_16x16x32_bf16 v[72:75], v[116:119], v[20:23], 0
    v_mfma_f32_16x16x32_bf16 v[68:71], v[104:107], v[24:27], v[68:71]
    v_mfma_f32_16x16x32_bf16 v[72:75], v[120:123], v[24:27], v[72:75]
    v_mfma_f32_16x16x32_bf16 v[68:71], v[108:111], v[28:31], v[68:71]
    v_mfma_f32_16x16x32_bf16 v[72:75], v[124:127], v[28:31], v[72:75]
    v_mfma_f32_16x16x32_bf16 v[68:71], v[112:115], v[32:35], v[68:71]
    v_mfma_f32_16x16x32_bf16 v[72:75], v[128:131], v[32:35], v[72:75]
    v_mfma_f32_16x16x32_bf16 v[76:79], v[140:143], v[20:23], 0
    v_mfma_f32_16x16x32_bf16 v[80:83], v[156:159], v[20:23], 0
    v_mfma_f32_16x16x32_bf16 v[76:79], v[144:147], v[24:27], v[76:79]
    v_mfma_f32_16x16x32_bf16 v[80:83], v[160:163], v[24:27], v[80:83]
    v_mfma_f32_16x16x32_bf16 v[76:79], v[148:151], v[28:31], v[76:79]
    v_mfma_f32_16x16x32_bf16 v[80:83], v[164:167], v[28:31], v[80:83]
    v_mfma_f32_16x16x32_bf16 v[76:79], v[152:155], v[32:35], v[76:79]
    v_mfma_f32_16x16x32_bf16 v[80:83], v[168:171], v[32:35], v[80:83]
    v_mfma_f32_16x16x32_bf16 v[84:87], v[180:183], v[20:23], 0
    v_mfma_f32_16x16x32_bf16 v[88:91], v[196:199], v[20:23], 0
    v_mfma_f32_16x16x32_bf16 v[84:87], v[184:187], v[24:27], v[84:87]
    v_mfma_f32_16x16x32_bf16 v[88:91], v[200:203], v[24:27], v[88:91]
    v_mfma_f32_16x16x32_bf16 v[84:87], v[188:191], v[28:31], v[84:87]
    v_mfma_f32_16x16x32_bf16 v[88:91], v[204:207], v[28:31], v[88:91]
    v_mfma_f32_16x16x32_bf16 v[84:87], v[192:195], v[32:35], v[84:87]
    v_mfma_f32_16x16x32_bf16 v[88:91], v[208:211], v[32:35], v[88:91]
    v_mfma_f32_16x16x32_bf16 v[92:95], v[212:215], v[20:23], 0
    v_mfma_f32_16x16x32_bf16 v[96:99], v[228:231], v[20:23], 0
    v_mfma_f32_16x16x32_bf16 v[92:95], v[216:219], v[24:27], v[92:95]
    v_mfma_f32_16x16x32_bf16 v[96:99], v[232:235], v[24:27], v[96:99]
    v_mfma_f32_16x16x32_bf16 v[92:95], v[220:223], v[28:31], v[92:95]
    v_mfma_f32_16x16x32_bf16 v[96:99], v[236:239], v[28:31], v[96:99]
    v_mfma_f32_16x16x32_bf16 v[92:95], v[224:227], v[32:35], v[92:95]
    v_mfma_f32_16x16x32_bf16 v[96:99], v[240:243], v[32:35], v[96:99]
    v_mfma_f32_16x16x32_bf16 v[100:103], v[36:39], v[20:23], 0
    v_mfma_f32_16x16x32_bf16 v[104:107], v[52:55], v[20:23], 0
    v_mfma_f32_16x16x32_bf16 v[100:103], v[40:43], v[24:27], v[100:103]
    v_mfma_f32_16x16x32_bf16 v[104:107], v[56:59], v[24:27], v[104:107]
    v_mfma_f32_16x16x32_bf16 v[100:103], v[44:47], v[28:31], v[100:103]
    v_mfma_f32_16x16x32_bf16 v[104:107], v[60:63], v[28:31], v[104:107]
    v_mfma_f32_16x16x32_bf16 v[100:103], v[48:51], v[32:35], v[100:103]
    v_mfma_f32_16x16x32_bf16 v[104:107], v[64:67], v[32:35], v[104:107]
    s_waitcnt vmcnt(16)
    ds_read_b128 v[36:39], v7 offset:16384
    ds_read_b128 v[40:43], v8 offset:16384
    ds_read_b128 v[44:47], v9 offset:16384
    ds_read_b128 v[48:51], v10 offset:16384
    ds_read_b128 v[52:55], v7 offset:20480
    ds_read_b128 v[56:59], v8 offset:20480
    ds_read_b128 v[60:63], v9 offset:20480
    ds_read_b128 v[64:67], v10 offset:20480
    s_waitcnt lgkmcnt(0)
    s_add_u32 m0, s68, 16384
    s_mov_b32 s74, 65536
    buffer_load_dwordx4 v1, s[44:47], s74 offen offset:0 nt lds
    buffer_load_dwordx4 v2, s[44:47], s74 offen offset:1024 nt lds
    buffer_load_dwordx4 v3, s[44:47], s74 offen offset:2048 nt lds
    buffer_load_dwordx4 v4, s[44:47], s74 offen offset:3072 nt lds
    s_add_u32 m0, s68, 20480
    s_mov_b32 s74, 69632
    buffer_load_dwordx4 v1, s[44:47], s74 offen offset:0 nt lds
    buffer_load_dwordx4 v2, s[44:47], s74 offen offset:1024 nt lds
    buffer_load_dwordx4 v3, s[44:47], s74 offen offset:2048 nt lds
    buffer_load_dwordx4 v4, s[44:47], s74 offen offset:3072 nt lds
    v_mfma_f32_16x16x32_bf16 v[108:111], v[36:39], v[20:23], 0
    v_mfma_f32_16x16x32_bf16 v[112:115], v[52:55], v[20:23], 0
    v_mfma_f32_16x16x32_bf16 v[108:111], v[40:43], v[24:27], v[108:111]
    v_mfma_f32_16x16x32_bf16 v[112:115], v[56:59], v[24:27], v[112:115]
    v_mfma_f32_16x16x32_bf16 v[108:111], v[44:47], v[28:31], v[108:111]
    v_mfma_f32_16x16x32_bf16 v[112:115], v[60:63], v[28:31], v[112:115]
    v_mfma_f32_16x16x32_bf16 v[108:111], v[48:51], v[32:35], v[108:111]
    v_mfma_f32_16x16x32_bf16 v[112:115], v[64:67], v[32:35], v[112:115]
    s_waitcnt vmcnt(16)
    ds_read_b128 v[36:39], v7 offset:0
    ds_read_b128 v[40:43], v8 offset:0
    ds_read_b128 v[44:47], v9 offset:0
    ds_read_b128 v[48:51], v10 offset:0
    ds_read_b128 v[52:55], v7 offset:4096
    ds_read_b128 v[56:59], v8 offset:4096
    ds_read_b128 v[60:63], v9 offset:4096
    ds_read_b128 v[64:67], v10 offset:4096
    s_waitcnt lgkmcnt(0)
    s_add_u32 m0, s68, 0
    s_mov_b32 s74, 0
    buffer_load_dwordx4 v5, s[48:51], s74 offen offset:0 nt lds
    buffer_load_dwordx4 v6, s[48:51], s74 offen offset:1024 nt lds
    buffer_load_dwordx4 v5, s[48:51], s74 offen offset:2048 nt lds
    buffer_load_dwordx4 v6, s[48:51], s74 offen offset:3072 nt lds
    s_add_u32 m0, s68, 4096
    s_mov_b32 s74, 4096
    buffer_load_dwordx4 v5, s[48:51], s74 offen offset:0 nt lds
    buffer_load_dwordx4 v6, s[48:51], s74 offen offset:1024 nt lds
    buffer_load_dwordx4 v5, s[48:51], s74 offen offset:2048 nt lds
    buffer_load_dwordx4 v6, s[48:51], s74 offen offset:3072 nt lds
    v_mfma_f32_16x16x32_bf16 v[116:119], v[36:39], v[20:23], 0
    v_mfma_f32_16x16x32_bf16 v[120:123], v[52:55], v[20:23], 0
    v_mfma_f32_16x16x32_bf16 v[116:119], v[40:43], v[24:27], v[116:119]
    v_mfma_f32_16x16x32_bf16 v[120:123], v[56:59], v[24:27], v[120:123]
    v_mfma_f32_16x16x32_bf16 v[116:119], v[44:47], v[28:31], v[116:119]
    v_mfma_f32_16x16x32_bf16 v[120:123], v[60:63], v[28:31], v[120:123]
    v_mfma_f32_16x16x32_bf16 v[116:119], v[48:51], v[32:35], v[116:119]
    v_mfma_f32_16x16x32_bf16 v[120:123], v[64:67], v[32:35], v[120:123]
    s_waitcnt vmcnt(16)
    ds_read_b128 v[36:39], v7 offset:8192
    ds_read_b128 v[40:43], v8 offset:8192
    ds_read_b128 v[44:47], v9 offset:8192
    ds_read_b128 v[48:51], v10 offset:8192
    ds_read_b128 v[52:55], v7 offset:12288
    ds_read_b128 v[56:59], v8 offset:12288
    ds_read_b128 v[60:63], v9 offset:12288
    ds_read_b128 v[64:67], v10 offset:12288
    s_waitcnt lgkmcnt(0)
    s_add_u32 m0, s68, 8192
    s_mov_b32 s74, 8192
    buffer_load_dwordx4 v5, s[48:51], s74 offen offset:0 nt lds
    buffer_load_dwordx4 v6, s[48:51], s74 offen offset:1024 nt lds
    buffer_load_dwordx4 v5, s[48:51], s74 offen offset:2048 nt lds
    buffer_load_dwordx4 v6, s[48:51], s74 offen offset:3072 nt lds
    s_add_u32 m0, s68, 12288
    s_mov_b32 s74, 12288
    buffer_load_dwordx4 v5, s[48:51], s74 offen offset:0 nt lds
    buffer_load_dwordx4 v6, s[48:51], s74 offen offset:1024 nt lds
    buffer_load_dwordx4 v5, s[48:51], s74 offen offset:2048 nt lds
    buffer_load_dwordx4 v6, s[48:51], s74 offen offset:3072 nt lds
    v_mfma_f32_16x16x32_bf16 v[124:127], v[36:39], v[20:23], 0
    v_mfma_f32_16x16x32_bf16 v[128:131], v[52:55], v[20:23], 0
    v_mfma_f32_16x16x32_bf16 v[124:127], v[40:43], v[24:27], v[124:127]
    v_mfma_f32_16x16x32_bf16 v[128:131], v[56:59], v[24:27], v[128:131]
    v_mfma_f32_16x16x32_bf16 v[124:127], v[44:47], v[28:31], v[124:127]
    v_mfma_f32_16x16x32_bf16 v[128:131], v[60:63], v[28:31], v[128:131]
    v_mfma_f32_16x16x32_bf16 v[124:127], v[48:51], v[32:35], v[124:127]
    v_mfma_f32_16x16x32_bf16 v[128:131], v[64:67], v[32:35], v[128:131]
    s_waitcnt vmcnt(16)
    ds_read_b128 v[36:39], v7 offset:16384
    ds_read_b128 v[40:43], v8 offset:16384
    ds_read_b128 v[44:47], v9 offset:16384
    ds_read_b128 v[48:51], v10 offset:16384
    ds_read_b128 v[52:55], v7 offset:20480
    ds_read_b128 v[56:59], v8 offset:20480
    ds_read_b128 v[60:63], v9 offset:20480
    ds_read_b128 v[64:67], v10 offset:20480
    s_waitcnt lgkmcnt(0)
    s_add_u32 m0, s68, 16384
    s_mov_b32 s74, 16384
    buffer_load_dwordx4 v5, s[48:51], s74 offen offset:0 nt lds
    buffer_load_dwordx4 v6, s[48:51], s74 offen offset:1024 nt lds
    buffer_load_dwordx4 v5, s[48:51], s74 offen offset:2048 nt lds
    buffer_load_dwordx4 v6, s[48:51], s74 offen offset:3072 nt lds
    s_add_u32 m0, s68, 20480
    s_mov_b32 s74, 20480
    buffer_load_dwordx4 v5, s[48:51], s74 offen offset:0 nt lds
    buffer_load_dwordx4 v6, s[48:51], s74 offen offset:1024 nt lds
    buffer_load_dwordx4 v5, s[48:51], s74 offen offset:2048 nt lds
    buffer_load_dwordx4 v6, s[48:51], s74 offen offset:3072 nt lds
    v_mfma_f32_16x16x32_bf16 v[132:135], v[36:39], v[20:23], 0
    v_mfma_f32_16x16x32_bf16 v[136:139], v[52:55], v[20:23], 0
    v_mfma_f32_16x16x32_bf16 v[132:135], v[40:43], v[24:27], v[132:135]
    v_mfma_f32_16x16x32_bf16 v[136:139], v[56:59], v[24:27], v[136:139]
    v_mfma_f32_16x16x32_bf16 v[132:135], v[44:47], v[28:31], v[132:135]
    v_mfma_f32_16x16x32_bf16 v[136:139], v[60:63], v[28:31], v[136:139]
    v_mfma_f32_16x16x32_bf16 v[132:135], v[48:51], v[32:35], v[132:135]
    v_mfma_f32_16x16x32_bf16 v[136:139], v[64:67], v[32:35], v[136:139]
    s_nop 7
    v_max3_f32 v172, v68, v69, v70
    v_max3_f32 v174, v71, v72, v73
    v_max3_f32 v172, v172, v74, v75
    v_max3_f32 v174, v174, v76, v77
    v_max3_f32 v172, v172, v78, v79
    v_max3_f32 v174, v174, v80, v81
    v_max3_f32 v172, v172, v82, v83
    v_max3_f32 v174, v174, v84, v85
    v_max3_f32 v172, v172, v86, v87
    v_max3_f32 v174, v174, v88, v89
    v_max3_f32 v172, v172, v90, v91
    v_max3_f32 v174, v174, v92, v93
    v_max3_f32 v172, v172, v94, v95
    v_max3_f32 v174, v174, v96, v97
    v_max3_f32 v172, v172, v98, v99
    v_max3_f32 v174, v174, v100, v101
    v_max3_f32 v172, v172, v102, v103
    v_max3_f32 v174, v174, v104, v105
    v_max3_f32 v172, v172, v106, v107
    v_max3_f32 v174, v174, v108, v109
    v_max3_f32 v172, v172, v110, v111
    v_max3_f32 v174, v174, v112, v113
    v_max3_f32 v172, v172, v114, v115
    v_max3_f32 v174, v174, v116, v117
    v_max3_f32 v172, v172, v118, v119
    v_max3_f32 v174, v174, v120, v121
    v_max3_f32 v172, v172, v122, v123
    v_max3_f32 v174, v174, v124, v125
    v_max3_f32 v172, v172, v126, v127
    v_max3_f32 v174, v174, v128, v129
    v_max3_f32 v172, v172, v130, v131
    v_max3_f32 v174, v174, v132, v133
    v_max3_f32 v172, v172, v134, v135
    v_max3_f32 v174, v174, v136, v137
    v_max3_f32 v172, v172, v138, v139
    v_max_f32 v172, v172, v174
    v_mov_b32 v174, v172
    s_nop 1
    v_permlane16_swap_b32 v172, v174
    s_nop 1
    v_max_f32 v172, v172, v174
    v_mov_b32 v174, v172
    s_nop 1
    v_permlane32_swap_b32 v172, v174
    s_nop 1
    v_max_f32 v172, v172, v174
    v_mul_f32 v175, s65, v172
    v_mov_b32 v173, 0
    v_mov_b32 v176, 0
    v_fma_f32 v68, v68, s64, v175
    v_fma_f32 v69, v69, s64, v175
    v_fma_f32 v70, v70, s64, v175
    v_fma_f32 v71, v71, s64, v175
    v_fma_f32 v72, v72, s64, v175
    v_fma_f32 v73, v73, s64, v175
    v_fma_f32 v74, v74, s64, v175
    v_fma_f32 v75, v75, s64, v175
    v_fma_f32 v76, v76, s64, v175
    v_fma_f32 v77, v77, s64, v175
    v_fma_f32 v78, v78, s64, v175
    v_fma_f32 v79, v79, s64, v175
    v_fma_f32 v80, v80, s64, v175
    v_fma_f32 v81, v81, s64, v175
    v_fma_f32 v82, v82, s64, v175
    v_fma_f32 v83, v83, s64, v175
    v_fma_f32 v84, v84, s64, v175
    v_fma_f32 v85, v85, s64, v175
    v_fma_f32 v86, v86, s64, v175
    v_fma_f32 v87, v87, s64, v175
    v_fma_f32 v88, v88, s64, v175
    v_fma_f32 v89, v89, s64, v175
    v_fma_f32 v90, v90, s64, v175
    v_fma_f32 v91, v91, s64, v175
    v_fma_f32 v92, v92, s64, v175
    v_fma_f32 v93, v93, s64, v175
    v_fma_f32 v94, v94, s64, v175
    v_fma_f32 v95, v95, s64, v175
    v_fma_f32 v96, v96, s64, v175
    v_fma_f32 v97, v97, s64, v175
    v_fma_f32 v98, v98, s64, v175
    v_fma_f32 v99, v99, s64, v175
    v_fma_f32 v100, v100, s64, v175
    v_fma_f32 v101, v101, s64, v175
    v_fma_f32 v102, v102, s64, v175
    v_fma_f32 v103, v103, s64, v175
    v_fma_f32 v104, v104, s64, v175
    v_fma_f32 v105, v105, s64, v175
    v_fma_f32 v106, v106, s64, v175
    v_fma_f32 v107, v107, s64, v175
    v_fma_f32 v108, v108, s64, v175
    v_fma_f32 v109, v109, s64, v175
    v_fma_f32 v110, v110, s64, v175
    v_fma_f32 v111, v111, s64, v175
    v_fma_f32 v112, v112, s64, v175
    v_fma_f32 v113, v113, s64, v175
    v_fma_f32 v114, v114, s64, v175
    v_fma_f32 v115, v115, s64, v175
    v_fma_f32 v116, v116, s64, v175
    v_fma_f32 v117, v117, s64, v175
    v_fma_f32 v118, v118, s64, v175
    v_fma_f32 v119, v119, s64, v175
    v_fma_f32 v120, v120, s64, v175
    v_fma_f32 v121, v121, s64, v175
    v_fma_f32 v122, v122, s64, v175
    v_fma_f32 v123, v123, s64, v175
    v_fma_f32 v124, v124, s64, v175
    v_fma_f32 v125, v125, s64, v175
    v_fma_f32 v126, v126, s64, v175
    v_fma_f32 v127, v127, s64, v175
    v_fma_f32 v128, v128, s64, v175
    v_fma_f32 v129, v129, s64, v175
    v_fma_f32 v130, v130, s64, v175
    v_fma_f32 v131, v131, s64, v175
    v_fma_f32 v132, v132, s64, v175
    v_fma_f32 v133, v133, s64, v175
    v_fma_f32 v134, v134, s64, v175
    v_fma_f32 v135, v135, s64, v175
    v_fma_f32 v136, v136, s64, v175
    v_fma_f32 v137, v137, s64, v175
    v_fma_f32 v138, v138, s64, v175
    v_fma_f32 v139, v139, s64, v175
    v_exp_f32 v68, v68
    v_exp_f32 v69, v69
    v_exp_f32 v70, v70
    v_exp_f32 v71, v71
    v_exp_f32 v72, v72
    v_exp_f32 v73, v73
    v_exp_f32 v74, v74
    v_exp_f32 v75, v75
    v_exp_f32 v76, v76
    v_exp_f32 v77, v77
    v_exp_f32 v78, v78
    v_exp_f32 v79, v79
    v_exp_f32 v80, v80
    v_exp_f32 v81, v81
    v_exp_f32 v82, v82
    v_exp_f32 v83, v83
    v_exp_f32 v84, v84
    v_exp_f32 v85, v85
    v_exp_f32 v86, v86
    v_exp_f32 v87, v87
    v_exp_f32 v88, v88
    v_exp_f32 v89, v89
    v_exp_f32 v90, v90
    v_exp_f32 v91, v91
    v_exp_f32 v92, v92
    v_exp_f32 v93, v93
    v_exp_f32 v94, v94
    v_exp_f32 v95, v95
    v_exp_f32 v96, v96
    v_exp_f32 v97, v97
    v_exp_f32 v98, v98
    v_exp_f32 v99, v99
    v_exp_f32 v100, v100
    v_exp_f32 v101, v101
    v_exp_f32 v102, v102
    v_exp_f32 v103, v103
    v_exp_f32 v104, v104
    v_exp_f32 v105, v105
    v_exp_f32 v106, v106
    v_exp_f32 v107, v107
    v_exp_f32 v108, v108
    v_exp_f32 v109, v109
    v_exp_f32 v110, v110
    v_exp_f32 v111, v111
    v_exp_f32 v112, v112
    v_exp_f32 v113, v113
    v_exp_f32 v114, v114
    v_exp_f32 v115, v115
    v_exp_f32 v116, v116
    v_exp_f32 v117, v117
    v_exp_f32 v118, v118
    v_exp_f32 v119, v119
    v_exp_f32 v120, v120
    v_exp_f32 v121, v121
    v_exp_f32 v122, v122
    v_exp_f32 v123, v123
    v_exp_f32 v124, v124
    v_exp_f32 v125, v125
    v_exp_f32 v126, v126
    v_exp_f32 v127, v127
    v_exp_f32 v128, v128
    v_exp_f32 v129, v129
    v_exp_f32 v130, v130
    v_exp_f32 v131, v131
    v_exp_f32 v132, v132
    v_exp_f32 v133, v133
    v_exp_f32 v134, v134
    v_exp_f32 v135, v135
    v_exp_f32 v136, v136
    v_exp_f32 v137, v137
    v_exp_f32 v138, v138
    v_exp_f32 v139, v139
    v_add_f32 v173, v173, v68
    v_add_f32 v176, v176, v69
    v_add_f32 v173, v173, v70
    v_add_f32 v176, v176, v71
    v_add_f32 v173, v173, v72
    v_add_f32 v176, v176, v73
    v_add_f32 v173, v173, v74
    v_add_f32 v176, v176, v75
    v_add_f32 v173, v173, v76
    v_add_f32 v176, v176, v77
    v_add_f32 v173, v173, v78
    v_add_f32 v176, v176, v79
    v_add_f32 v173, v173, v80
    v_add_f32 v176, v176, v81
    v_add_f32 v173, v173, v82
    v_add_f32 v176, v176, v83
    v_add_f32 v173, v173, v84
    v_add_f32 v176, v176, v85
    v_add_f32 v173, v173, v86
    v_add_f32 v176, v176, v87
    v_add_f32 v173, v173, v88
    v_add_f32 v176, v176, v89
    v_add_f32 v173, v173, v90
    v_add_f32 v176, v176, v91
    v_add_f32 v173, v173, v92
    v_add_f32 v176, v176, v93
    v_add_f32 v173, v173, v94
    v_add_f32 v176, v176, v95
    v_add_f32 v173, v173, v96
    v_add_f32 v176, v176, v97
    v_add_f32 v173, v173, v98
    v_add_f32 v176, v176, v99
    v_add_f32 v173, v173, v100
    v_add_f32 v176, v176, v101
    v_add_f32 v173, v173, v102
    v_add_f32 v176, v176, v103
    v_add_f32 v173, v173, v104
    v_add_f32 v176, v176, v105
    v_add_f32 v173, v173, v106
    v_add_f32 v176, v176, v107
    v_add_f32 v173, v173, v108
    v_add_f32 v176, v176, v109
    v_add_f32 v173, v173, v110
    v_add_f32 v176, v176, v111
    v_add_f32 v173, v173, v112
    v_add_f32 v176, v176, v113
    v_add_f32 v173, v173, v114
    v_add_f32 v176, v176, v115
    v_add_f32 v173, v173, v116
    v_add_f32 v176, v176, v117
    v_add_f32 v173, v173, v118
    v_add_f32 v176, v176, v119
    v_add_f32 v173, v173, v120
    v_add_f32 v176, v176, v121
    v_add_f32 v173, v173, v122
    v_add_f32 v176, v176, v123
    v_add_f32 v173, v173, v124
    v_add_f32 v176, v176, v125
    v_add_f32 v173, v173, v126
    v_add_f32 v176, v176, v127
    v_add_f32 v173, v173, v128
    v_add_f32 v176, v176, v129
    v_add_f32 v173, v173, v130
    v_add_f32 v176, v176, v131
    v_add_f32 v173, v173, v132
    v_add_f32 v176, v176, v133
    v_add_f32 v173, v173, v134
    v_add_f32 v176, v176, v135
    v_add_f32 v173, v173, v136
    v_add_f32 v176, v176, v137
    v_add_f32 v173, v173, v138
    v_add_f32 v176, v176, v139
    v_cvt_pk_bf16_f32 v68, v68, v69
    v_cvt_pk_bf16_f32 v69, v70, v71
    v_cvt_pk_bf16_f32 v70, v72, v73
    v_cvt_pk_bf16_f32 v71, v74, v75
    v_cvt_pk_bf16_f32 v72, v76, v77
    v_cvt_pk_bf16_f32 v73, v78, v79
    v_cvt_pk_bf16_f32 v74, v80, v81
    v_cvt_pk_bf16_f32 v75, v82, v83
    v_cvt_pk_bf16_f32 v76, v84, v85
    v_cvt_pk_bf16_f32 v77, v86, v87
    v_cvt_pk_bf16_f32 v78, v88, v89
    v_cvt_pk_bf16_f32 v79, v90, v91
    v_cvt_pk_bf16_f32 v80, v92, v93
    v_cvt_pk_bf16_f32 v81, v94, v95
    v_cvt_pk_bf16_f32 v82, v96, v97
    v_cvt_pk_bf16_f32 v83, v98, v99
    v_cvt_pk_bf16_f32 v84, v100, v101
    v_cvt_pk_bf16_f32 v85, v102, v103
    v_cvt_pk_bf16_f32 v86, v104, v105
    v_cvt_pk_bf16_f32 v87, v106, v107
    v_cvt_pk_bf16_f32 v88, v108, v109
    v_cvt_pk_bf16_f32 v89, v110, v111
    v_cvt_pk_bf16_f32 v90, v112, v113
    v_cvt_pk_bf16_f32 v91, v114, v115
    v_cvt_pk_bf16_f32 v92, v116, v117
    v_cvt_pk_bf16_f32 v93, v118, v119
    v_cvt_pk_bf16_f32 v94, v120, v121
    v_cvt_pk_bf16_f32 v95, v122, v123
    v_cvt_pk_bf16_f32 v96, v124, v125
    v_cvt_pk_bf16_f32 v97, v126, v127
    v_cvt_pk_bf16_f32 v98, v128, v129
    v_cvt_pk_bf16_f32 v99, v130, v131
    v_cvt_pk_bf16_f32 v100, v132, v133
    v_cvt_pk_bf16_f32 v101, v134, v135
    v_cvt_pk_bf16_f32 v102, v136, v137
    v_cvt_pk_bf16_f32 v103, v138, v139
    v_add_f32 v173, v173, v176
    v_mov_b32 v174, v173
    s_nop 1
    v_permlane16_swap_b32 v173, v174
    s_nop 1
    v_add_f32 v173, v173, v174
    v_mov_b32 v174, v173
    s_nop 1
    v_permlane32_swap_b32 v173, v174
    s_nop 1
    v_add_f32 v173, v173, v174
    s_waitcnt vmcnt(16)
    ds_read_b64_tr_b16 v[36:37], v11 offset:0
    ds_read_b64_tr_b16 v[38:39], v11 offset:4096
    ds_read_b64_tr_b16 v[40:41], v12 offset:0
    ds_read_b64_tr_b16 v[42:43], v12 offset:4096
    ds_read_b64_tr_b16 v[44:45], v13 offset:0
    ds_read_b64_tr_b16 v[46:47], v13 offset:4096
    ds_read_b64_tr_b16 v[48:49], v14 offset:0
    ds_read_b64_tr_b16 v[50:51], v14 offset:4096
    ds_read_b64_tr_b16 v[52:53], v15 offset:0
    ds_read_b64_tr_b16 v[54:55], v15 offset:4096
    ds_read_b64_tr_b16 v[56:57], v16 offset:0
    ds_read_b64_tr_b16 v[58:59], v16 offset:4096
    ds_read_b64_tr_b16 v[60:61], v17 offset:0
    ds_read_b64_tr_b16 v[62:63], v17 offset:4096
    ds_read_b64_tr_b16 v[64:65], v18 offset:0
    ds_read_b64_tr_b16 v[66:67], v18 offset:4096
    s_waitcnt lgkmcnt(0)
    s_add_u32 m0, s68, 0
    s_mov_b32 s74, 24576
    buffer_load_dwordx4 v5, s[48:51], s74 offen offset:0 nt lds
    buffer_load_dwordx4 v6, s[48:51], s74 offen offset:1024 nt lds
    buffer_load_dwordx4 v5, s[48:51], s74 offen offset:2048 nt lds
    buffer_load_dwordx4 v6, s[48:51], s74 offen offset:3072 nt lds
    s_add_u32 m0, s68, 4096
    s_mov_b32 s74, 28672
    buffer_load_dwordx4 v5, s[48:51], s74 offen offset:0 nt lds
    buffer_load_dwordx4 v6, s[48:51], s74 offen offset:1024 nt lds
    buffer_load_dwordx4 v5, s[48:51], s74 offen offset:2048 nt lds
    buffer_load_dwordx4 v6, s[48:51], s74 offen offset:3072 nt lds
    v_mfma_f32_16x16x32_bf16 v[140:143], v[36:39], v[68:71], 0
    v_mfma_f32_16x16x32_bf16 v[144:147], v[40:43], v[68:71], 0
    v_mfma_f32_16x16x32_bf16 v[148:151], v[44:47], v[68:71], 0
    v_mfma_f32_16x16x32_bf16 v[152:155], v[48:51], v[68:71], 0
    v_mfma_f32_16x16x32_bf16 v[156:159], v[52:55], v[68:71], 0
    v_mfma_f32_16x16x32_bf16 v[160:163], v[56:59], v[68:71], 0
    v_mfma_f32_16x16x32_bf16 v[164:167], v[60:63], v[68:71], 0
    v_mfma_f32_16x16x32_bf16 v[168:171], v[64:67], v[68:71], 0
    s_waitcnt vmcnt(16)
    ds_read_b64_tr_b16 v[36:37], v11 offset:8192
    ds_read_b64_tr_b16 v[38:39], v11 offset:12288
    ds_read_b64_tr_b16 v[40:41], v12 offset:8192
    ds_read_b64_tr_b16 v[42:43], v12 offset:12288
    ds_read_b64_tr_b16 v[44:45], v13 offset:8192
    ds_read_b64_tr_b16 v[46:47], v13 offset:12288
    ds_read_b64_tr_b16 v[48:49], v14 offset:8192
    ds_read_b64_tr_b16 v[50:51], v14 offset:12288
    ds_read_b64_tr_b16 v[52:53], v15 offset:8192
    ds_read_b64_tr_b16 v[54:55], v15 offset:12288
    ds_read_b64_tr_b16 v[56:57], v16 offset:8192
    ds_read_b64_tr_b16 v[58:59], v16 offset:12288
    ds_read_b64_tr_b16 v[60:61], v17 offset:8192
    ds_read_b64_tr_b16 v[62:63], v17 offset:12288
    ds_read_b64_tr_b16 v[64:65], v18 offset:8192
    ds_read_b64_tr_b16 v[66:67], v18 offset:12288
    s_waitcnt lgkmcnt(0)
    s_add_u32 m0, s68, 8192
    s_mov_b32 s74, 32768
    buffer_load_dwordx4 v5, s[48:51], s74 offen offset:0 nt lds
    buffer_load_dwordx4 v6, s[48:51], s74 offen offset:1024 nt lds
    buffer_load_dwordx4 v5, s[48:51], s74 offen offset:2048 nt lds
    buffer_load_dwordx4 v6, s[48:51], s74 offen offset:3072 nt lds
    s_add_u32 m0, s68, 12288
    s_mov_b32 s74, 36864
    buffer_load_dwordx4 v5, s[48:51], s74 offen offset:0 nt lds
    buffer_load_dwordx4 v6, s[48:51], s74 offen offset:1024 nt lds
    buffer_load_dwordx4 v5, s[48:51], s74 offen offset:2048 nt lds
    buffer_load_dwordx4 v6, s[48:51], s74 offen offset:3072 nt lds
    v_mfma_f32_16x16x32_bf16 v[140:143], v[36:39], v[72:75], v[140:143]
    v_mfma_f32_16x16x32_bf16 v[144:147], v[40:43], v[72:75], v[144:147]
    v_mfma_f32_16x16x32_bf16 v[148:151], v[44:47], v[72:75], v[148:151]
    v_mfma_f32_16x16x32_bf16 v[152:155], v[48:51], v[72:75], v[152:155]
    v_mfma_f32_16x16x32_bf16 v[156:159], v[52:55], v[72:75], v[156:159]
    v_mfma_f32_16x16x32_bf16 v[160:163], v[56:59], v[72:75], v[160:163]
    v_mfma_f32_16x16x32_bf16 v[164:167], v[60:63], v[72:75], v[164:167]
    v_mfma_f32_16x16x32_bf16 v[168:171], v[64:67], v[72:75], v[168:171]
    s_waitcnt vmcnt(16)
    ds_read_b64_tr_b16 v[36:37], v11 offset:16384
    ds_read_b64_tr_b16 v[38:39], v11 offset:20480
    ds_read_b64_tr_b16 v[40:41], v12 offset:16384
    ds_read_b64_tr_b16 v[42:43], v12 offset:20480
    ds_read_b64_tr_b16 v[44:45], v13 offset:16384
    ds_read_b64_tr_b16 v[46:47], v13 offset:20480
    ds_read_b64_tr_b16 v[48:49], v14 offset:16384
    ds_read_b64_tr_b16 v[50:51], v14 offset:20480
    ds_read_b64_tr_b16 v[52:53], v15 offset:16384
    ds_read_b64_tr_b16 v[54:55], v15 offset:20480
    ds_read_b64_tr_b16 v[56:57], v16 offset:16384
    ds_read_b64_tr_b16 v[58:59], v16 offset:20480
    ds_read_b64_tr_b16 v[60:61], v17 offset:16384
    ds_read_b64_tr_b16 v[62:63], v17 offset:20480
    ds_read_b64_tr_b16 v[64:65], v18 offset:16384
    ds_read_b64_tr_b16 v[66:67], v18 offset:20480
    s_waitcnt lgkmcnt(0)
    s_add_u32 m0, s68, 16384
    s_mov_b32 s74, 40960
    buffer_load_dwordx4 v5, s[48:51], s74 offen offset:0 nt lds
    buffer_load_dwordx4 v6, s[48:51], s74 offen offset:1024 nt lds
    buffer_load_dwordx4 v5, s[48:51], s74 offen offset:2048 nt lds
    buffer_load_dwordx4 v6, s[48:51], s74 offen offset:3072 nt lds
    s_add_u32 m0, s68, 20480
    s_mov_b32 s74, 45056
    buffer_load_dwordx4 v5, s[48:51], s74 offen offset:0 nt lds
    buffer_load_dwordx4 v6, s[48:51], s74 offen offset:1024 nt lds
    buffer_load_dwordx4 v5, s[48:51], s74 offen offset:2048 nt lds
    buffer_load_dwordx4 v6, s[48:51], s74 offen offset:3072 nt lds
    v_mfma_f32_16x16x32_bf16 v[140:143], v[36:39], v[76:79], v[140:143]
    v_mfma_f32_16x16x32_bf16 v[144:147], v[40:43], v[76:79], v[144:147]
    v_mfma_f32_16x16x32_bf16 v[148:151], v[44:47], v[76:79], v[148:151]
    v_mfma_f32_16x16x32_bf16 v[152:155], v[48:51], v[76:79], v[152:155]
    v_mfma_f32_16x16x32_bf16 v[156:159], v[52:55], v[76:79], v[156:159]
    v_mfma_f32_16x16x32_bf16 v[160:163], v[56:59], v[76:79], v[160:163]
    v_mfma_f32_16x16x32_bf16 v[164:167], v[60:63], v[76:79], v[164:167]
    v_mfma_f32_16x16x32_bf16 v[168:171], v[64:67], v[76:79], v[168:171]
    s_waitcnt vmcnt(16)
    ds_read_b64_tr_b16 v[36:37], v11 offset:0
    ds_read_b64_tr_b16 v[38:39], v11 offset:4096
    ds_read_b64_tr_b16 v[40:41], v12 offset:0
    ds_read_b64_tr_b16 v[42:43], v12 offset:4096
    ds_read_b64_tr_b16 v[44:45], v13 offset:0
    ds_read_b64_tr_b16 v[46:47], v13 offset:4096
    ds_read_b64_tr_b16 v[48:49], v14 offset:0
    ds_read_b64_tr_b16 v[50:51], v14 offset:4096
    ds_read_b64_tr_b16 v[52:53], v15 offset:0
    ds_read_b64_tr_b16 v[54:55], v15 offset:4096
    ds_read_b64_tr_b16 v[56:57], v16 offset:0
    ds_read_b64_tr_b16 v[58:59], v16 offset:4096
    ds_read_b64_tr_b16 v[60:61], v17 offset:0
    ds_read_b64_tr_b16 v[62:63], v17 offset:4096
    ds_read_b64_tr_b16 v[64:65], v18 offset:0
    ds_read_b64_tr_b16 v[66:67], v18 offset:4096
    s_waitcnt lgkmcnt(0)
    s_add_u32 m0, s68, 0
    s_mov_b32 s74, 49152
    buffer_load_dwordx4 v5, s[48:51], s74 offen offset:0 nt lds
    buffer_load_dwordx4 v6, s[48:51], s74 offen offset:1024 nt lds
    buffer_load_dwordx4 v5, s[48:51], s74 offen offset:2048 nt lds
    buffer_load_dwordx4 v6, s[48:51], s74 offen offset:3072 nt lds
    s_add_u32 m0, s68, 4096
    s_mov_b32 s74, 53248
    buffer_load_dwordx4 v5, s[48:51], s74 offen offset:0 nt lds
    buffer_load_dwordx4 v6, s[48:51], s74 offen offset:1024 nt lds
    buffer_load_dwordx4 v5, s[48:51], s74 offen offset:2048 nt lds
    buffer_load_dwordx4 v6, s[48:51], s74 offen offset:3072 nt lds
    v_mfma_f32_16x16x32_bf16 v[140:143], v[36:39], v[80:83], v[140:143]
    v_mfma_f32_16x16x32_bf16 v[144:147], v[40:43], v[80:83], v[144:147]
    v_mfma_f32_16x16x32_bf16 v[148:151], v[44:47], v[80:83], v[148:151]
    v_mfma_f32_16x16x32_bf16 v[152:155], v[48:51], v[80:83], v[152:155]
    v_mfma_f32_16x16x32_bf16 v[156:159], v[52:55], v[80:83], v[156:159]
    v_mfma_f32_16x16x32_bf16 v[160:163], v[56:59], v[80:83], v[160:163]
    v_mfma_f32_16x16x32_bf16 v[164:167], v[60:63], v[80:83], v[164:167]
    v_mfma_f32_16x16x32_bf16 v[168:171], v[64:67], v[80:83], v[168:171]
    s_waitcnt vmcnt(16)
    ds_read_b64_tr_b16 v[36:37], v11 offset:8192
    ds_read_b64_tr_b16 v[38:39], v11 offset:12288
    ds_read_b64_tr_b16 v[40:41], v12 offset:8192
    ds_read_b64_tr_b16 v[42:43], v12 offset:12288
    ds_read_b64_tr_b16 v[44:45], v13 offset:8192
    ds_read_b64_tr_b16 v[46:47], v13 offset:12288
    ds_read_b64_tr_b16 v[48:49], v14 offset:8192
    ds_read_b64_tr_b16 v[50:51], v14 offset:12288
    ds_read_b64_tr_b16 v[52:53], v15 offset:8192
    ds_read_b64_tr_b16 v[54:55], v15 offset:12288
    ds_read_b64_tr_b16 v[56:57], v16 offset:8192
    ds_read_b64_tr_b16 v[58:59], v16 offset:12288
    ds_read_b64_tr_b16 v[60:61], v17 offset:8192
    ds_read_b64_tr_b16 v[62:63], v17 offset:12288
    ds_read_b64_tr_b16 v[64:65], v18 offset:8192
    ds_read_b64_tr_b16 v[66:67], v18 offset:12288
    s_waitcnt lgkmcnt(0)
    s_add_u32 m0, s68, 8192
    s_mov_b32 s74, 57344
    buffer_load_dwordx4 v5, s[48:51], s74 offen offset:0 nt lds
    buffer_load_dwordx4 v6, s[48:51], s74 offen offset:1024 nt lds
    buffer_load_dwordx4 v5, s[48:51], s74 offen offset:2048 nt lds
    buffer_load_dwordx4 v6, s[48:51], s74 offen offset:3072 nt lds
    s_add_u32 m0, s68, 12288
    s_mov_b32 s74, 61440
    buffer_load_dwordx4 v5, s[48:51], s74 offen offset:0 nt lds
    buffer_load_dwordx4 v6, s[48:51], s74 offen offset:1024 nt lds
    buffer_load_dwordx4 v5, s[48:51], s74 offen offset:2048 nt lds
    buffer_load_dwordx4 v6, s[48:51], s74 offen offset:3072 nt lds
    v_mfma_f32_16x16x32_bf16 v[140:143], v[36:39], v[84:87], v[140:143]
    v_mfma_f32_16x16x32_bf16 v[144:147], v[40:43], v[84:87], v[144:147]
    v_mfma_f32_16x16x32_bf16 v[148:151], v[44:47], v[84:87], v[148:151]
    v_mfma_f32_16x16x32_bf16 v[152:155], v[48:51], v[84:87], v[152:155]
    v_mfma_f32_16x16x32_bf16 v[156:159], v[52:55], v[84:87], v[156:159]
    v_mfma_f32_16x16x32_bf16 v[160:163], v[56:59], v[84:87], v[160:163]
    v_mfma_f32_16x16x32_bf16 v[164:167], v[60:63], v[84:87], v[164:167]
    v_mfma_f32_16x16x32_bf16 v[168:171], v[64:67], v[84:87], v[168:171]
    s_waitcnt vmcnt(16)
    ds_read_b64_tr_b16 v[36:37], v11 offset:16384
    ds_read_b64_tr_b16 v[38:39], v11 offset:20480
    ds_read_b64_tr_b16 v[40:41], v12 offset:16384
    ds_read_b64_tr_b16 v[42:43], v12 offset:20480
    ds_read_b64_tr_b16 v[44:45], v13 offset:16384
    ds_read_b64_tr_b16 v[46:47], v13 offset:20480
    ds_read_b64_tr_b16 v[48:49], v14 offset:16384
    ds_read_b64_tr_b16 v[50:51], v14 offset:20480
    ds_read_b64_tr_b16 v[52:53], v15 offset:16384
    ds_read_b64_tr_b16 v[54:55], v15 offset:20480
    ds_read_b64_tr_b16 v[56:57], v16 offset:16384
    ds_read_b64_tr_b16 v[58:59], v16 offset:20480
    ds_read_b64_tr_b16 v[60:61], v17 offset:16384
    ds_read_b64_tr_b16 v[62:63], v17 offset:20480
    ds_read_b64_tr_b16 v[64:65], v18 offset:16384
    ds_read_b64_tr_b16 v[66:67], v18 offset:20480
    s_waitcnt lgkmcnt(0)
    s_add_u32 m0, s68, 16384
    s_mov_b32 s74, 65536
    buffer_load_dwordx4 v5, s[48:51], s74 offen offset:0 nt lds
    buffer_load_dwordx4 v6, s[48:51], s74 offen offset:1024 nt lds
    buffer_load_dwordx4 v5, s[48:51], s74 offen offset:2048 nt lds
    buffer_load_dwordx4 v6, s[48:51], s74 offen offset:3072 nt lds
    s_add_u32 m0, s68, 20480
    s_mov_b32 s74, 69632
    buffer_load_dwordx4 v5, s[48:51], s74 offen offset:0 nt lds
    buffer_load_dwordx4 v6, s[48:51], s74 offen offset:1024 nt lds
    buffer_load_dwordx4 v5, s[48:51], s74 offen offset:2048 nt lds
    buffer_load_dwordx4 v6, s[48:51], s74 offen offset:3072 nt lds
    v_mfma_f32_16x16x32_bf16 v[140:143], v[36:39], v[88:91], v[140:143]
    v_mfma_f32_16x16x32_bf16 v[144:147], v[40:43], v[88:91], v[144:147]
    v_mfma_f32_16x16x32_bf16 v[148:151], v[44:47], v[88:91], v[148:151]
    v_mfma_f32_16x16x32_bf16 v[152:155], v[48:51], v[88:91], v[152:155]
    v_mfma_f32_16x16x32_bf16 v[156:159], v[52:55], v[88:91], v[156:159]
    v_mfma_f32_16x16x32_bf16 v[160:163], v[56:59], v[88:91], v[160:163]
    v_mfma_f32_16x16x32_bf16 v[164:167], v[60:63], v[88:91], v[164:167]
    v_mfma_f32_16x16x32_bf16 v[168:171], v[64:67], v[88:91], v[168:171]
    s_waitcnt vmcnt(16)
    ds_read_b64_tr_b16 v[36:37], v11 offset:0
    ds_read_b64_tr_b16 v[38:39], v11 offset:4096
    ds_read_b64_tr_b16 v[40:41], v12 offset:0
    ds_read_b64_tr_b16 v[42:43], v12 offset:4096
    ds_read_b64_tr_b16 v[44:45], v13 offset:0
    ds_read_b64_tr_b16 v[46:47], v13 offset:4096
    ds_read_b64_tr_b16 v[48:49], v14 offset:0
    ds_read_b64_tr_b16 v[50:51], v14 offset:4096
    ds_read_b64_tr_b16 v[52:53], v15 offset:0
    ds_read_b64_tr_b16 v[54:55], v15 offset:4096
    ds_read_b64_tr_b16 v[56:57], v16 offset:0
    ds_read_b64_tr_b16 v[58:59], v16 offset:4096
    ds_read_b64_tr_b16 v[60:61], v17 offset:0
    ds_read_b64_tr_b16 v[62:63], v17 offset:4096
    ds_read_b64_tr_b16 v[64:65], v18 offset:0
    ds_read_b64_tr_b16 v[66:67], v18 offset:4096
    s_waitcnt lgkmcnt(0)
    v_mfma_f32_16x16x32_bf16 v[140:143], v[36:39], v[92:95], v[140:143]
    v_mfma_f32_16x16x32_bf16 v[144:147], v[40:43], v[92:95], v[144:147]
    v_mfma_f32_16x16x32_bf16 v[148:151], v[44:47], v[92:95], v[148:151]
    v_mfma_f32_16x16x32_bf16 v[152:155], v[48:51], v[92:95], v[152:155]
    v_mfma_f32_16x16x32_bf16 v[156:159], v[52:55], v[92:95], v[156:159]
    v_mfma_f32_16x16x32_bf16 v[160:163], v[56:59], v[92:95], v[160:163]
    v_mfma_f32_16x16x32_bf16 v[164:167], v[60:63], v[92:95], v[164:167]
    v_mfma_f32_16x16x32_bf16 v[168:171], v[64:67], v[92:95], v[168:171]
    s_waitcnt vmcnt(8)
    ds_read_b64_tr_b16 v[36:37], v11 offset:8192
    ds_read_b64_tr_b16 v[38:39], v11 offset:12288
    ds_read_b64_tr_b16 v[40:41], v12 offset:8192
    ds_read_b64_tr_b16 v[42:43], v12 offset:12288
    ds_read_b64_tr_b16 v[44:45], v13 offset:8192
    ds_read_b64_tr_b16 v[46:47], v13 offset:12288
    ds_read_b64_tr_b16 v[48:49], v14 offset:8192
    ds_read_b64_tr_b16 v[50:51], v14 offset:12288
    ds_read_b64_tr_b16 v[52:53], v15 offset:8192
    ds_read_b64_tr_b16 v[54:55], v15 offset:12288
    ds_read_b64_tr_b16 v[56:57], v16 offset:8192
    ds_read_b64_tr_b16 v[58:59], v16 offset:12288
    ds_read_b64_tr_b16 v[60:61], v17 offset:8192
    ds_read_b64_tr_b16 v[62:63], v17 offset:12288
    ds_read_b64_tr_b16 v[64:65], v18 offset:8192
    ds_read_b64_tr_b16 v[66:67], v18 offset:12288
    s_waitcnt lgkmcnt(0)
    v_mfma_f32_16x16x32_bf16 v[140:143], v[36:39], v[96:99], v[140:143]
    v_mfma_f32_16x16x32_bf16 v[144:147], v[40:43], v[96:99], v[144:147]
    v_mfma_f32_16x16x32_bf16 v[148:151], v[44:47], v[96:99], v[148:151]
    v_mfma_f32_16x16x32_bf16 v[152:155], v[48:51], v[96:99], v[152:155]
    v_mfma_f32_16x16x32_bf16 v[156:159], v[52:55], v[96:99], v[156:159]
    v_mfma_f32_16x16x32_bf16 v[160:163], v[56:59], v[96:99], v[160:163]
    v_mfma_f32_16x16x32_bf16 v[164:167], v[60:63], v[96:99], v[164:167]
    v_mfma_f32_16x16x32_bf16 v[168:171], v[64:67], v[96:99], v[168:171]
    s_waitcnt vmcnt(0)
    ds_read_b64_tr_b16 v[36:37], v11 offset:16384
    ds_read_b64_tr_b16 v[38:39], v11 offset:20480
    ds_read_b64_tr_b16 v[40:41], v12 offset:16384
    ds_read_b64_tr_b16 v[42:43], v12 offset:20480
    ds_read_b64_tr_b16 v[44:45], v13 offset:16384
    ds_read_b64_tr_b16 v[46:47], v13 offset:20480
    ds_read_b64_tr_b16 v[48:49], v14 offset:16384
    ds_read_b64_tr_b16 v[50:51], v14 offset:20480
    ds_read_b64_tr_b16 v[52:53], v15 offset:16384
    ds_read_b64_tr_b16 v[54:55], v15 offset:20480
    ds_read_b64_tr_b16 v[56:57], v16 offset:16384
    ds_read_b64_tr_b16 v[58:59], v16 offset:20480
    ds_read_b64_tr_b16 v[60:61], v17 offset:16384
    ds_read_b64_tr_b16 v[62:63], v17 offset:20480
    ds_read_b64_tr_b16 v[64:65], v18 offset:16384
    ds_read_b64_tr_b16 v[66:67], v18 offset:20480
    s_waitcnt lgkmcnt(0)
    v_mfma_f32_16x16x32_bf16 v[140:143], v[36:39], v[100:103], v[140:143]
    v_mfma_f32_16x16x32_bf16 v[144:147], v[40:43], v[100:103], v[144:147]
    v_mfma_f32_16x16x32_bf16 v[148:151], v[44:47], v[100:103], v[148:151]
    v_mfma_f32_16x16x32_bf16 v[152:155], v[48:51], v[100:103], v[152:155]
    v_mfma_f32_16x16x32_bf16 v[156:159], v[52:55], v[100:103], v[156:159]
    v_mfma_f32_16x16x32_bf16 v[160:163], v[56:59], v[100:103], v[160:163]
    v_mfma_f32_16x16x32_bf16 v[164:167], v[60:63], v[100:103], v[164:167]
    v_mfma_f32_16x16x32_bf16 v[168:171], v[64:67], v[100:103], v[168:171]
L_scommon:
    s_mov_b32 s72, 0x000f000f
    s_mov_b32 s73, 0x000f000f
    s_mov_b64 exec, 15
    ds_write_b64 v245, v[172:173] offset:2048
    s_nop 5
    s_mov_b64 exec, s[72:73]
    ds_write_b128 v244, v[140:143] offset:0
    ds_write_b128 v244, v[144:147] offset:64
    ds_write_b128 v244, v[148:151] offset:128
    ds_write_b128 v244, v[152:155] offset:192
    ds_write_b128 v244, v[156:159] offset:256
    ds_write_b128 v244, v[160:163] offset:320
    ds_write_b128 v244, v[164:167] offset:384
    ds_write_b128 v244, v[168:171] offset:448
    s_mov_b64 exec, -1
    s_waitcnt lgkmcnt(0)
    s_barrier
    ds_read_b64 v[52:53], v248 offset:2048
    ds_read_b64 v[54:55], v248 offset:26624
    ds_read_b64 v[56:57], v249 offset:2048
    ds_read_b64 v[58:59], v249 offset:26624
    ds_read_b128 v[36:39], v246 offset:0
    ds_read_b128 v[40:43], v246 offset:24576
    ds_read_b128 v[44:47], v247 offset:0
    ds_read_b128 v[48:51], v247 offset:24576
    s_waitcnt lgkmcnt(4)
    v_max3_f32 v60, v52, v54, v56
    v_max_f32 v60, v60, v58
    v_mul_f32 v62, s65, v60
    v_fma_f32 v52, v52, s64, v62
    v_fma_f32 v54, v54, s64, v62
    v_fma_f32 v56, v56, s64, v62
    v_fma_f32 v58, v58, s64, v62
    v_exp_f32 v52, v52
    v_exp_f32 v54, v54
    v_exp_f32 v56, v56
    v_exp_f32 v58, v58
    s_nop 0
    v_mul_f32 v61, v52, v53
    v_fma_f32 v61, v54, v55, v61
    v_fma_f32 v61, v56, v57, v61
    v_fma_f32 v61, v58, v59, v61
    s_waitcnt lgkmcnt(0)
    v_mul_f32 v36, v52, v36
    v_mul_f32 v37, v52, v37
    v_mul_f32 v38, v52, v38
    v_mul_f32 v39, v52, v39
    v_fma_f32 v36, v54, v40, v36
    v_fma_f32 v37, v54, v41, v37
    v_fma_f32 v38, v54, v42, v38
    v_fma_f32 v39, v54, v43, v39
    v_fma_f32 v36, v56, v44, v36
    v_fma_f32 v37, v56, v45, v37
    v_fma_f32 v38, v56, v46, v38
    v_fma_f32 v39, v56, v47, v39
    v_fma_f32 v36, v58, v48, v36
    v_fma_f32 v37, v58, v49, v37
    v_fma_f32 v38, v58, v50, v38
    v_fma_f32 v39, v58, v51, v39
    v_cmp_eq_u32 vcc, 32, v0
    v_cndmask_b32 v36, v36, v60, vcc
    v_cndmask_b32 v37, v37, v61, vcc
    v_lshlrev_b32 v60, 8, v60
    v_cndmask_b32 v38, v38, v60, vcc
    v_cndmask_b32 v39, v39, v61, vcc
    v_and_or_b32 v36, v36, s5, v252
    v_and_or_b32 v37, v37, s5, v253
    v_and_or_b32 v38, v38, s5, v254
    v_and_or_b32 v39, v39, s5, v255
    s_mov_b32 s72, -1
    s_mov_b32 s73, 1
    s_mov_b64 exec, s[72:73]
    buffer_store_dwordx4 v[36:39], v250, s[52:55], 0 offen sc1
    s_barrier
    s_waitcnt vmcnt(0)
    s_endpgm
L_wwave:
    s_waitcnt lgkmcnt(0)
    s_cmp_lg_u32 s34, 0
    s_cselect_b64 s[8:9], s[16:17], s[8:9]
    s_cselect_b64 s[10:11], s[18:19], s[10:11]
    s_cselect_b64 s[12:13], s[20:21], s[12:13]
    s_cselect_b64 s[14:15], s[22:23], s[14:15]
    s_mov_b32 s52, s30
    s_mov_b32 s53, s31
    s_mov_b32 s54, 8388608
    s_mov_b32 s55, 0x00020000
    s_mov_b32 s5, 0xffffff00
    s_lshl_b32 s66, s35, 2
    s_add_u32 s66, s66, s40
    s_lshl_b32 s66, s66, 17
    s_lshl_b32 s67, s41, 8
    s_add_u32 s66, s66, s67
    s_add_u32 s44, s14, s66
    s_addc_u32 s45, s15, 0
    s_mov_b32 s46, 130304
    s_mov_b32 s47, 0x00020000
    v_lshrrev_b32 v12, 4, v0
    v_and_b32 v13, 15, v0
    v_lshlrev_b32 v1, 1, v12
    v_xor_b32 v1, v1, v13
    v_lshlrev_b32 v1, 4, v1
    v_lshlrev_b32 v2, 1, v12
    v_add_u32 v2, 8, v2
    v_xor_b32 v2, v2, v13
    v_lshlrev_b32 v2, 4, v2
    v_mul_u32_u24 v12, 1024, v12
    v_add_u32 v1, v1, v12
    v_add_u32 v2, v2, v12
    v_lshrrev_b32 v13, 2, v0
    v_and_b32 v14, 7, v13
    v_lshlrev_b32 v14, 5, v14
    v_lshlrev_b32 v13, 8, v13
    v_add_u32 v13, v13, v14
    v_and_b32 v14, 3, v0
    v_lshlrev_b32 v14, 3, v14
    v_add_u32 v13, v13, v14
    v_xor_b32 v3, 0, v13
    v_xor_b32 v4, 32, v13
    v_xor_b32 v5, 64, v13
    v_xor_b32 v6, 96, v13
    v_xor_b32 v7, 128, v13
    v_xor_b32 v8, 160, v13
    v_xor_b32 v9, 192, v13
    v_xor_b32 v10, 224, v13
    v_add_u32 v3, 131072, v3
    v_add_u32 v4, 131072, v4
    v_add_u32 v5, 131072, v5
    v_add_u32 v6, 131072, v6
    v_add_u32 v7, 131072, v7
    v_add_u32 v8, 131072, v8
    v_add_u32 v9, 131072, v9
    v_add_u32 v10, 131072, v10
    s_mov_b32 s48, s32
    s_mov_b32 s49, s33
    s_mov_b32 s50, 8192
    s_mov_b32 s51, 0x00020000
    s_mov_b32 s56, s24
    s_mov_b32 s57, s25
    s_mov_b32 s58, 1024
    s_mov_b32 s59, 0x00020000
    v_lshrrev_b32 v13, 4, v0
    v_lshlrev_b32 v13, 4, v13
    v_and_b32 v12, 7, v0
    v_lshlrev_b32 v12, 10, v12
    v_add_u32 v12, v12, v13
    s_load_dword s4, s[30:31], 0
    s_barrier
    s_waitcnt lgkmcnt(0)
    s_add_u32 s16, s4, 1
    s_and_b32 s16, s16, 0xff
    s_add_u32 s17, s4, 65
    s_and_b32 s17, s17, 0xff
    s_add_u32 s18, s4, 129
    s_and_b32 s18, s18, 0xff
    s_add_u32 s19, s4, 193
    s_and_b32 s19, s19, 0xff
    buffer_load_dwordx4 v[128:131], v12, s[48:51], 0 offen offset:0
    buffer_load_dwordx4 v[132:135], v12, s[48:51], 0 offen offset:64
    buffer_load_dwordx4 v[136:139], v12, s[48:51], 0 offen offset:128
    buffer_load_dwordx4 v[140:143], v12, s[48:51], 0 offen offset:192
    buffer_load_dwordx4 v[144:147], v12, s[48:51], 0 offen offset:256
    buffer_load_dwordx4 v[148:151], v12, s[48:51], 0 offen offset:320
    buffer_load_dwordx4 v[152:155], v12, s[48:51], 0 offen offset:384
    buffer_load_dwordx4 v[156:159], v12, s[48:51], 0 offen offset:448
    buffer_load_dwordx4 v[160:163], v12, s[48:51], 0 offen offset:512
    buffer_load_dwordx4 v[164:167], v12, s[48:51], 0 offen offset:576
    buffer_load_dwordx4 v[168:171], v12, s[48:51], 0 offen offset:640
    buffer_load_dwordx4 v[172:175], v12, s[48:51], 0 offen offset:704
    buffer_load_dwordx4 v[176:179], v12, s[48:51], 0 offen offset:768
    buffer_load_dwordx4 v[180:183], v12, s[48:51], 0 offen offset:832
    buffer_load_dwordx4 v[184:187], v12, s[48:51], 0 offen offset:896
    buffer_load_dwordx4 v[188:191], v12, s[48:51], 0 offen offset:960
    buffer_load_dwordx4 v[192:195], v13, s[56:59], 0 offen offset:0
    buffer_load_dwordx4 v[196:199], v13, s[56:59], 0 offen offset:64
    buffer_load_dwordx4 v[200:203], v13, s[56:59], 0 offen offset:128
    buffer_load_dwordx4 v[204:207], v13, s[56:59], 0 offen offset:192
    buffer_load_dwordx4 v[208:211], v13, s[56:59], 0 offen offset:256
    buffer_load_dwordx4 v[212:215], v13, s[56:59], 0 offen offset:320
    buffer_load_dwordx4 v[216:219], v13, s[56:59], 0 offen offset:384
    buffer_load_dwordx4 v[220:223], v13, s[56:59], 0 offen offset:448
    buffer_load_dwordx4 v[224:227], v13, s[56:59], 0 offen offset:512
    buffer_load_dwordx4 v[228:231], v13, s[56:59], 0 offen offset:576
    buffer_load_dwordx4 v[232:235], v13, s[56:59], 0 offen offset:640
    buffer_load_dwordx4 v[236:239], v13, s[56:59], 0 offen offset:704
    buffer_load_dwordx4 v[240:243], v13, s[56:59], 0 offen offset:768
    buffer_load_dwordx4 v[244:247], v13, s[56:59], 0 offen offset:832
    buffer_load_dwordx4 v[248:251], v13, s[56:59], 0 offen offset:896
    buffer_load_dwordx4 v[252:255], v13, s[56:59], 0 offen offset:960
    s_waitcnt vmcnt(0)
    v_mfma_f32_16x16x32_bf16 v[84:87], v[192:195], v[128:131], 0
    v_mfma_f32_16x16x32_bf16 v[84:87], v[196:199], v[132:135], v[84:87]
    v_mfma_f32_16x16x32_bf16 v[84:87], v[200:203], v[136:139], v[84:87]
    v_mfma_f32_16x16x32_bf16 v[84:87], v[204:207], v[140:143], v[84:87]
    v_mfma_f32_16x16x32_bf16 v[84:87], v[208:211], v[144:147], v[84:87]
    v_mfma_f32_16x16x32_bf16 v[84:87], v[212:215], v[148:151], v[84:87]
    v_mfma_f32_16x16x32_bf16 v[84:87], v[216:219], v[152:155], v[84:87]
    v_mfma_f32_16x16x32_bf16 v[84:87], v[220:223], v[156:159], v[84:87]
    v_mfma_f32_16x16x32_bf16 v[84:87], v[224:227], v[160:163], v[84:87]
    v_mfma_f32_16x16x32_bf16 v[84:87], v[228:231], v[164:167], v[84:87]
    v_mfma_f32_16x16x32_bf16 v[84:87], v[232:235], v[168:171], v[84:87]
    v_mfma_f32_16x16x32_bf16 v[84:87], v[236:239], v[172:175], v[84:87]
    v_mfma_f32_16x16x32_bf16 v[84:87], v[240:243], v[176:179], v[84:87]
    v_mfma_f32_16x16x32_bf16 v[84:87], v[244:247], v[180:183], v[84:87]
    v_mfma_f32_16x16x32_bf16 v[84:87], v[248:251], v[184:187], v[84:87]
    v_mfma_f32_16x16x32_bf16 v[84:87], v[252:255], v[188:191], v[84:87]
    s_nop 7
    v_mul_f32 v16, 0xbfb8aa3b, v84
    v_exp_f32 v16, v16
    s_nop 0
    v_add_f32 v16, 1.0, v16
    v_rcp_f32 v16, v16
    s_nop 0
    v_sub_f32 v14, 1.0, v16
    s_cmp_lg_u32 s34, 0
    s_cselect_b64 vcc, -1, 0
    v_cndmask_b32 v16, v16, v14, vcc
    s_barrier
    s_mov_b32 m0, 131072
    s_mov_b32 s74, 0
    buffer_load_dwordx4 v1, s[44:47], s74 offen offset:0 nt lds
    s_mov_b32 s75, 3072
    buffer_load_dwordx4 v2, s[44:47], s75 offen offset:1024 nt lds
    s_mov_b32 s76, 6144
    buffer_load_dwordx4 v1, s[44:47], s76 offen offset:2048 nt lds
    s_mov_b32 s77, 9216
    buffer_load_dwordx4 v2, s[44:47], s77 offen offset:3072 nt lds
    s_mov_b32 m0, 135168
    s_mov_b32 s74, 16384
    buffer_load_dwordx4 v1, s[44:47], s74 offen offset:0 nt lds
    s_mov_b32 s75, 19456
    buffer_load_dwordx4 v2, s[44:47], s75 offen offset:1024 nt lds
    s_mov_b32 s76, 22528
    buffer_load_dwordx4 v1, s[44:47], s76 offen offset:2048 nt lds
    s_mov_b32 s77, 25600
    buffer_load_dwordx4 v2, s[44:47], s77 offen offset:3072 nt lds
    s_mov_b32 m0, 139264
    s_mov_b32 s74, 32768
    buffer_load_dwordx4 v1, s[44:47], s74 offen offset:0 nt lds
    s_mov_b32 s75, 35840
    buffer_load_dwordx4 v2, s[44:47], s75 offen offset:1024 nt lds
    s_mov_b32 s76, 38912
    buffer_load_dwordx4 v1, s[44:47], s76 offen offset:2048 nt lds
    s_mov_b32 s77, 41984
    buffer_load_dwordx4 v2, s[44:47], s77 offen offset:3072 nt lds
    s_mov_b32 m0, 143360
    s_mov_b32 s74, 49152
    buffer_load_dwordx4 v1, s[44:47], s74 offen offset:0 nt lds
    s_mov_b32 s75, 52224
    buffer_load_dwordx4 v2, s[44:47], s75 offen offset:1024 nt lds
    s_mov_b32 s76, 55296
    buffer_load_dwordx4 v1, s[44:47], s76 offen offset:2048 nt lds
    s_mov_b32 s77, 58368
    buffer_load_dwordx4 v2, s[44:47], s77 offen offset:3072 nt lds
    s_mov_b32 m0, 147456
    s_mov_b32 s74, 65536
    buffer_load_dwordx4 v1, s[44:47], s74 offen offset:0 nt lds
    s_mov_b32 s75, 68608
    buffer_load_dwordx4 v2, s[44:47], s75 offen offset:1024 nt lds
    s_mov_b32 s76, 71680
    buffer_load_dwordx4 v1, s[44:47], s76 offen offset:2048 nt lds
    s_mov_b32 s77, 74752
    buffer_load_dwordx4 v2, s[44:47], s77 offen offset:3072 nt lds
    s_mov_b32 m0, 151552
    s_mov_b32 s74, 81920
    buffer_load_dwordx4 v1, s[44:47], s74 offen offset:0 nt lds
    s_mov_b32 s75, 84992
    buffer_load_dwordx4 v2, s[44:47], s75 offen offset:1024 nt lds
    s_mov_b32 s76, 88064
    buffer_load_dwordx4 v1, s[44:47], s76 offen offset:2048 nt lds
    s_mov_b32 s77, 91136
    buffer_load_dwordx4 v2, s[44:47], s77 offen offset:3072 nt lds
    s_mov_b32 m0, 155648
    s_mov_b32 s74, 98304
    buffer_load_dwordx4 v1, s[44:47], s74 offen offset:0 nt lds
    s_mov_b32 s75, 101376
    buffer_load_dwordx4 v2, s[44:47], s75 offen offset:1024 nt lds
    s_mov_b32 s76, 104448
    buffer_load_dwordx4 v1, s[44:47], s76 offen offset:2048 nt lds
    s_mov_b32 s77, 107520
    buffer_load_dwordx4 v2, s[44:47], s77 offen offset:3072 nt lds
    s_mov_b32 m0, 159744
    s_mov_b32 s74, 114688
    buffer_load_dwordx4 v1, s[44:47], s74 offen offset:0 nt lds
    s_mov_b32 s75, 117760
    buffer_load_dwordx4 v2, s[44:47], s75 offen offset:1024 nt lds
    s_mov_b32 s76, 120832
    buffer_load_dwordx4 v1, s[44:47], s76 offen offset:2048 nt lds
    s_mov_b32 s77, 123904
    buffer_load_dwordx4 v2, s[44:47], s77 offen offset:3072 nt lds
    s_waitcnt vmcnt(0)
    ds_read_b64_tr_b16 v[128:129], v3 offset:0
    ds_read_b64_tr_b16 v[130:131], v3 offset:4096
    ds_read_b64_tr_b16 v[132:133], v4 offset:0
    ds_read_b64_tr_b16 v[134:135], v4 offset:4096
    ds_read_b64_tr_b16 v[136:137], v5 offset:0
    ds_read_b64_tr_b16 v[138:139], v5 offset:4096
    ds_read_b64_tr_b16 v[140:141], v6 offset:0
    ds_read_b64_tr_b16 v[142:143], v6 offset:4096
    ds_read_b64_tr_b16 v[144:145], v7 offset:0
    ds_read_b64_tr_b16 v[146:147], v7 offset:4096
    ds_read_b64_tr_b16 v[148:149], v8 offset:0
    ds_read_b64_tr_b16 v[150:151], v8 offset:4096
    ds_read_b64_tr_b16 v[152:153], v9 offset:0
    ds_read_b64_tr_b16 v[154:155], v9 offset:4096
    ds_read_b64_tr_b16 v[156:157], v10 offset:0
    ds_read_b64_tr_b16 v[158:159], v10 offset:4096
    s_waitcnt lgkmcnt(0)
    ds_read_b64_tr_b16 v[160:161], v3 offset:8192
    ds_read_b64_tr_b16 v[162:163], v3 offset:12288
    ds_read_b64_tr_b16 v[164:165], v4 offset:8192
    ds_read_b64_tr_b16 v[166:167], v4 offset:12288
    ds_read_b64_tr_b16 v[168:169], v5 offset:8192
    ds_read_b64_tr_b16 v[170:171], v5 offset:12288
    ds_read_b64_tr_b16 v[172:173], v6 offset:8192
    ds_read_b64_tr_b16 v[174:175], v6 offset:12288
    ds_read_b64_tr_b16 v[176:177], v7 offset:8192
    ds_read_b64_tr_b16 v[178:179], v7 offset:12288
    ds_read_b64_tr_b16 v[180:181], v8 offset:8192
    ds_read_b64_tr_b16 v[182:183], v8 offset:12288
    ds_read_b64_tr_b16 v[184:185], v9 offset:8192
    ds_read_b64_tr_b16 v[186:187], v9 offset:12288
    ds_read_b64_tr_b16 v[188:189], v10 offset:8192
    ds_read_b64_tr_b16 v[190:191], v10 offset:12288
    s_waitcnt lgkmcnt(0)
    ds_read_b64_tr_b16 v[192:193], v3 offset:16384
    ds_read_b64_tr_b16 v[194:195], v3 offset:20480
    ds_read_b64_tr_b16 v[196:197], v4 offset:16384
    ds_read_b64_tr_b16 v[198:199], v4 offset:20480
    ds_read_b64_tr_b16 v[200:201], v5 offset:16384
    ds_read_b64_tr_b16 v[202:203], v5 offset:20480
    ds_read_b64_tr_b16 v[204:205], v6 offset:16384
    ds_read_b64_tr_b16 v[206:207], v6 offset:20480
    ds_read_b64_tr_b16 v[208:209], v7 offset:16384
    ds_read_b64_tr_b16 v[210:211], v7 offset:20480
    ds_read_b64_tr_b16 v[212:213], v8 offset:16384
    ds_read_b64_tr_b16 v[214:215], v8 offset:20480
    ds_read_b64_tr_b16 v[216:217], v9 offset:16384
    ds_read_b64_tr_b16 v[218:219], v9 offset:20480
    ds_read_b64_tr_b16 v[220:221], v10 offset:16384
    ds_read_b64_tr_b16 v[222:223], v10 offset:20480
    s_waitcnt lgkmcnt(0)
    ds_read_b64_tr_b16 v[224:225], v3 offset:24576
    ds_read_b64_tr_b16 v[226:227], v3 offset:28672
    ds_read_b64_tr_b16 v[228:229], v4 offset:24576
    ds_read_b64_tr_b16 v[230:231], v4 offset:28672
    ds_read_b64_tr_b16 v[232:233], v5 offset:24576
    ds_read_b64_tr_b16 v[234:235], v5 offset:28672
    ds_read_b64_tr_b16 v[236:237], v6 offset:24576
    ds_read_b64_tr_b16 v[238:239], v6 offset:28672
    ds_read_b64_tr_b16 v[240:241], v7 offset:24576
    ds_read_b64_tr_b16 v[242:243], v7 offset:28672
    ds_read_b64_tr_b16 v[244:245], v8 offset:24576
    ds_read_b64_tr_b16 v[246:247], v8 offset:28672
    ds_read_b64_tr_b16 v[248:249], v9 offset:24576
    ds_read_b64_tr_b16 v[250:251], v9 offset:28672
    ds_read_b64_tr_b16 v[252:253], v10 offset:24576
    ds_read_b64_tr_b16 v[254:255], v10 offset:28672
    s_waitcnt lgkmcnt(0)
    v_and_b32 v12, 7, v0
    v_lshlrev_b32 v12, 1, v12
    v_lshrrev_b32 v13, 3, v0
    v_and_b32 v13, 1, v13
    v_add_u32 v12, v12, v13
    v_lshlrev_b32 v12, 12, v12
    s_lshl_b32 s66, s37, 16
    s_lshl_b32 s67, s40, 10
    s_add_u32 s66, s66, s67
    s_add_u32 s66, s66, 1048576
    v_add_u32 v12, s66, v12
    v_lshrrev_b32 v13, 4, v0
    v_lshlrev_b32 v13, 4, v13
    v_add_u32 v13, v12, v13
    v_lshrrev_b32 v7, 3, v0
    v_and_b32 v7, 1, v7
    v_lshlrev_b32 v7, 8, v7
    v_add_u32 v13, v13, v7
    v_xor_b32 v7, 0x1000, v13
    s_lshl_b32 s66, s37, 4
    s_add_u32 s66, s66, s36
    s_lshl_b32 s66, s66, 12
    s_add_u32 s66, s66, 2097152
    v_and_b32 v14, 7, v0
    v_lshlrev_b32 v14, 9, v14
    v_lshrrev_b32 v15, 4, v0
    v_lshlrev_b32 v15, 4, v15
    v_add_u32 v14, v14, v15
    v_add_u32 v14, s66, v14
    v_mov_b32 v24, s16
    v_mov_b32 v25, s17
    v_mov_b32 v26, s18
    v_mov_b32 v27, s19
    s_and_b32 s66, s2, 7
    s_lshr_b32 s67, s2, 3
    s_lshr_b32 s68, s67, 3
    s_lshl_b32 s68, s68, 12
    s_lshl_b32 s69, s66, 9
    s_add_u32 s68, s68, s69
    s_and_b32 s69, s67, 7
    s_lshl_b32 s69, s69, 6
    s_add_u32 s68, s68, s69
    v_lshrrev_b32 v5, 4, v0
    v_lshlrev_b32 v5, 16, v5
    v_lshrrev_b32 v6, 2, v0
    v_and_b32 v6, 3, v6
    v_lshlrev_b32 v6, 14, v6
    v_add_u32 v5, v5, v6
    v_and_b32 v6, 3, v0
    v_lshlrev_b32 v6, 4, v6
    v_add_u32 v5, v5, v6
    v_add_u32 v3, s68, v5
    s_mov_b32 s74, 2097152
    s_mov_b32 s75, 2359296
    s_mov_b32 s76, 2621440
    s_mov_b32 s77, 2883584
    s_mov_b32 s60, s26
    s_mov_b32 s61, s27
    s_mov_b32 s62, 8192
    s_mov_b32 s63, 0x00020000
    s_lshl_b32 s66, s66, 10
    s_lshl_b32 s67, s67, 5
    s_add_u32 s66, s66, s67
    v_and_b32 v4, 3, v0
    v_lshlrev_b32 v4, 3, v4
    v_lshrrev_b32 v5, 4, v0
    v_and_b32 v6, 1, v5
    v_lshlrev_b32 v6, 2, v6
    v_add_u32 v4, v4, v6
    v_lshrrev_b32 v5, 1, v5
    v_lshlrev_b32 v5, 1, v5
    v_add_u32 v4, v4, v5
    v_add_u32 v4, s66, v4
    s_barrier
    s_barrier
    s_mov_b32 s70, 200000
L_opoll:
    buffer_load_dwordx4 v[64:67], v12, s[52:55], 0 offen offset:512 sc1
    buffer_load_dwordx4 v[32:35], v13, s[52:55], 0 offen offset:0 sc1
    buffer_load_dwordx4 v[36:39], v13, s[52:55], 0 offen offset:64 sc1
    buffer_load_dwordx4 v[40:43], v13, s[52:55], 0 offen offset:128 sc1
    buffer_load_dwordx4 v[44:47], v13, s[52:55], 0 offen offset:192 sc1
    buffer_load_dwordx4 v[48:51], v7, s[52:55], 0 offen offset:0 sc1
    buffer_load_dwordx4 v[52:55], v7, s[52:55], 0 offen offset:64 sc1
    buffer_load_dwordx4 v[56:59], v7, s[52:55], 0 offen offset:128 sc1
    buffer_load_dwordx4 v[60:63], v7, s[52:55], 0 offen offset:192 sc1
    s_waitcnt vmcnt(8)
    v_xor_b32 v15, s16, v64
    v_bitop3_b32 v15, v15, v65, s17 bitop3:0xf6
    v_bitop3_b32 v15, v15, v66, s18 bitop3:0xf6
    v_bitop3_b32 v15, v15, v67, s19 bitop3:0xf6
    s_waitcnt vmcnt(7)
    v_bitop3_b32 v15, v15, v32, s16 bitop3:0xf6
    v_bitop3_b32 v15, v15, v33, s17 bitop3:0xf6
    v_bitop3_b32 v15, v15, v34, s18 bitop3:0xf6
    v_bitop3_b32 v15, v15, v35, s19 bitop3:0xf6
    s_waitcnt vmcnt(6)
    v_bitop3_b32 v15, v15, v36, s16 bitop3:0xf6
    v_bitop3_b32 v15, v15, v37, s17 bitop3:0xf6
    v_bitop3_b32 v15, v15, v38, s18 bitop3:0xf6
    v_bitop3_b32 v15, v15, v39, s19 bitop3:0xf6
    s_waitcnt vmcnt(5)
    v_bitop3_b32 v15, v15, v40, s16 bitop3:0xf6
    v_bitop3_b32 v15, v15, v41, s17 bitop3:0xf6
    v_bitop3_b32 v15, v15, v42, s18 bitop3:0xf6
    v_bitop3_b32 v15, v15, v43, s19 bitop3:0xf6
    s_waitcnt vmcnt(4)
    v_bitop3_b32 v15, v15, v44, s16 bitop3:0xf6
    v_bitop3_b32 v15, v15, v45, s17 bitop3:0xf6
    v_bitop3_b32 v15, v15, v46, s18 bitop3:0xf6
    v_bitop3_b32 v15, v15, v47, s19 bitop3:0xf6
    s_waitcnt vmcnt(3)
    v_bitop3_b32 v15, v15, v48, s16 bitop3:0xf6
    v_bitop3_b32 v15, v15, v49, s17 bitop3:0xf6
    v_bitop3_b32 v15, v15, v50, s18 bitop3:0xf6
    v_bitop3_b32 v15, v15, v51, s19 bitop3:0xf6
    s_waitcnt vmcnt(2)
    v_bitop3_b32 v15, v15, v52, s16 bitop3:0xf6
    v_bitop3_b32 v15, v15, v53, s17 bitop3:0xf6
    v_bitop3_b32 v15, v15, v54, s18 bitop3:0xf6
    v_bitop3_b32 v15, v15, v55, s19 bitop3:0xf6
    s_waitcnt vmcnt(1)
    v_bitop3_b32 v15, v15, v56, s16 bitop3:0xf6
    v_bitop3_b32 v15, v15, v57, s17 bitop3:0xf6
    v_bitop3_b32 v15, v15, v58, s18 bitop3:0xf6
    v_bitop3_b32 v15, v15, v59, s19 bitop3:0xf6
    s_waitcnt vmcnt(0)
    v_bitop3_b32 v15, v15, v60, s16 bitop3:0xf6
    v_bitop3_b32 v15, v15, v61, s17 bitop3:0xf6
    v_bitop3_b32 v15, v15, v62, s18 bitop3:0xf6
    v_bitop3_b32 v15, v15, v63, s19 bitop3:0xf6
    v_and_b32 v15, 0xff, v15
    v_cmp_ne_u32 vcc, 0, v15
    s_cbranch_vccz L_opoll_done
    s_mov_b64 exec, vcc
    s_sub_u32 s70, s70, 1
    s_cmp_lg_u32 s70, 0
    s_cbranch_scc1 L_opoll
L_opoll_done:
    s_mov_b64 exec, -1
    v_lshrrev_b32 v66, 8, v66
    v_and_b32 v66, 0xff, v66
    v_and_or_b32 v64, v64, s5, v66
    v_and_b32 v65, s5, v65
    v_and_b32 v32, s5, v32
    v_and_b32 v33, s5, v33
    v_mov_b32_dpp v20, v64 row_ror:8 row_mask:0xf bank_mask:0xf
    v_and_b32 v34, s5, v34
    v_max_f32 v20, v20, v64
    v_sub_f32 v21, v64, v20
    v_mul_f32 v21, s64, v21
    v_exp_f32 v21, v21
    v_and_b32 v35, s5, v35
    v_and_b32 v36, s5, v36
    v_mul_f32 v22, v21, v65
    v_and_b32 v37, s5, v37
    v_and_b32 v38, s5, v38
    v_add_f32_dpp v22, v22, v22 row_ror:8 row_mask:0xf bank_mask:0xf
    v_rcp_f32 v22, v22
    v_mul_f32 v21, v21, v16
    v_and_b32 v39, s5, v39
    v_and_b32 v40, s5, v40
    v_mul_f32 v22, v22, v21
    v_and_b32 v41, s5, v41
    v_and_b32 v42, s5, v42
    v_mov_b32_dpp v23, v22 row_ror:8 row_mask:0xf bank_mask:0xf
    v_and_b32 v43, s5, v43
    v_and_b32 v44, s5, v44
    v_and_b32 v45, s5, v45
    v_and_b32 v46, s5, v46
    v_and_b32 v47, s5, v47
    v_and_b32 v48, s5, v48
    v_and_b32 v49, s5, v49
    v_and_b32 v50, s5, v50
    v_and_b32 v51, s5, v51
    v_and_b32 v52, s5, v52
    v_and_b32 v53, s5, v53
    v_and_b32 v54, s5, v54
    v_and_b32 v55, s5, v55
    v_and_b32 v56, s5, v56
    v_and_b32 v57, s5, v57
    v_and_b32 v58, s5, v58
    v_and_b32 v59, s5, v59
    v_and_b32 v60, s5, v60
    v_and_b32 v61, s5, v61
    v_and_b32 v62, s5, v62
    v_and_b32 v63, s5, v63
    v_pk_mul_f32 v[32:33], v[32:33], v[22:23] op_sel_hi:[1,0]
    v_pk_mul_f32 v[34:35], v[34:35], v[22:23] op_sel_hi:[1,0]
    v_pk_mul_f32 v[36:37], v[36:37], v[22:23] op_sel_hi:[1,0]
    v_pk_mul_f32 v[38:39], v[38:39], v[22:23] op_sel_hi:[1,0]
    v_pk_fma_f32 v[32:33], v[48:49], v[22:23], v[32:33] op_sel:[0,1,0] op_sel_hi:[1,1,1]
    v_pk_fma_f32 v[34:35], v[50:51], v[22:23], v[34:35] op_sel:[0,1,0] op_sel_hi:[1,1,1]
    v_pk_fma_f32 v[36:37], v[52:53], v[22:23], v[36:37] op_sel:[0,1,0] op_sel_hi:[1,1,1]
    v_pk_fma_f32 v[38:39], v[54:55], v[22:23], v[38:39] op_sel:[0,1,0] op_sel_hi:[1,1,1]
    v_cvt_pk_bf16_f32 v68, v32, v33
    v_cvt_pk_bf16_f32 v69, v34, v35
    v_cvt_pk_bf16_f32 v70, v36, v37
    v_cvt_pk_bf16_f32 v71, v38, v39
    v_pk_mul_f32 v[40:41], v[40:41], v[22:23] op_sel_hi:[1,0]
    v_pk_mul_f32 v[42:43], v[42:43], v[22:23] op_sel_hi:[1,0]
    v_pk_mul_f32 v[44:45], v[44:45], v[22:23] op_sel_hi:[1,0]
    v_pk_mul_f32 v[46:47], v[46:47], v[22:23] op_sel_hi:[1,0]
    v_pk_fma_f32 v[40:41], v[56:57], v[22:23], v[40:41] op_sel:[0,1,0] op_sel_hi:[1,1,1]
    v_pk_fma_f32 v[42:43], v[58:59], v[22:23], v[42:43] op_sel:[0,1,0] op_sel_hi:[1,1,1]
    v_pk_fma_f32 v[44:45], v[60:61], v[22:23], v[44:45] op_sel:[0,1,0] op_sel_hi:[1,1,1]
    v_pk_fma_f32 v[46:47], v[62:63], v[22:23], v[46:47] op_sel:[0,1,0] op_sel_hi:[1,1,1]
    v_cvt_pk_bf16_f32 v72, v40, v41
    v_cvt_pk_bf16_f32 v73, v42, v43
    v_cvt_pk_bf16_f32 v74, v44, v45
    v_cvt_pk_bf16_f32 v75, v46, v47
    v_mfma_f32_16x16x32_bf16 v[84:87], v[128:131], v[68:71], 0
    v_mfma_f32_16x16x32_bf16 v[88:91], v[132:135], v[68:71], 0
    v_mfma_f32_16x16x32_bf16 v[92:95], v[136:139], v[68:71], 0
    v_mfma_f32_16x16x32_bf16 v[96:99], v[140:143], v[68:71], 0
    v_mfma_f32_16x16x32_bf16 v[100:103], v[144:147], v[68:71], 0
    v_mfma_f32_16x16x32_bf16 v[104:107], v[148:151], v[68:71], 0
    v_mfma_f32_16x16x32_bf16 v[108:111], v[152:155], v[68:71], 0
    v_mfma_f32_16x16x32_bf16 v[112:115], v[156:159], v[68:71], 0
    v_mov_b32_dpp v76, v68 row_ror:8 row_mask:0xf bank_mask:0xf
    v_mov_b32_dpp v77, v69 row_ror:8 row_mask:0xf bank_mask:0xf
    v_mov_b32_dpp v78, v70 row_ror:8 row_mask:0xf bank_mask:0xf
    v_mov_b32_dpp v79, v71 row_ror:8 row_mask:0xf bank_mask:0xf
    v_mov_b32_dpp v80, v72 row_ror:8 row_mask:0xf bank_mask:0xf
    v_mov_b32_dpp v81, v73 row_ror:8 row_mask:0xf bank_mask:0xf
    v_mov_b32_dpp v82, v74 row_ror:8 row_mask:0xf bank_mask:0xf
    v_mov_b32_dpp v83, v75 row_ror:8 row_mask:0xf bank_mask:0xf
    v_mfma_f32_16x16x32_bf16 v[84:87], v[160:163], v[72:75], v[84:87]
    v_mfma_f32_16x16x32_bf16 v[88:91], v[164:167], v[72:75], v[88:91]
    v_mfma_f32_16x16x32_bf16 v[92:95], v[168:171], v[72:75], v[92:95]
    v_mfma_f32_16x16x32_bf16 v[96:99], v[172:175], v[72:75], v[96:99]
    v_mfma_f32_16x16x32_bf16 v[100:103], v[176:179], v[72:75], v[100:103]
    v_mfma_f32_16x16x32_bf16 v[104:107], v[180:183], v[72:75], v[104:107]
    v_mfma_f32_16x16x32_bf16 v[108:111], v[184:187], v[72:75], v[108:111]
    v_mfma_f32_16x16x32_bf16 v[112:115], v[188:191], v[72:75], v[112:115]
    v_mfma_f32_16x16x32_bf16 v[84:87], v[192:195], v[76:79], v[84:87]
    v_mfma_f32_16x16x32_bf16 v[88:91], v[196:199], v[76:79], v[88:91]
    v_mfma_f32_16x16x32_bf16 v[92:95], v[200:203], v[76:79], v[92:95]
    v_mfma_f32_16x16x32_bf16 v[96:99], v[204:207], v[76:79], v[96:99]
    v_mfma_f32_16x16x32_bf16 v[100:103], v[208:211], v[76:79], v[100:103]
    v_mfma_f32_16x16x32_bf16 v[104:107], v[212:215], v[76:79], v[104:107]
    v_mfma_f32_16x16x32_bf16 v[108:111], v[216:219], v[76:79], v[108:111]
    v_mfma_f32_16x16x32_bf16 v[112:115], v[220:223], v[76:79], v[112:115]
    s_mov_b32 s72, 0x00ff00ff
    s_mov_b32 s73, 0x00ff00ff
    v_mfma_f32_16x16x32_bf16 v[84:87], v[224:227], v[80:83], v[84:87]
    v_mfma_f32_16x16x32_bf16 v[88:91], v[228:231], v[80:83], v[88:91]
    v_mfma_f32_16x16x32_bf16 v[92:95], v[232:235], v[80:83], v[92:95]
    v_mfma_f32_16x16x32_bf16 v[96:99], v[236:239], v[80:83], v[96:99]
    v_mfma_f32_16x16x32_bf16 v[100:103], v[240:243], v[80:83], v[100:103]
    v_mfma_f32_16x16x32_bf16 v[104:107], v[244:247], v[80:83], v[104:107]
    v_mfma_f32_16x16x32_bf16 v[108:111], v[248:251], v[80:83], v[108:111]
    v_mfma_f32_16x16x32_bf16 v[112:115], v[252:255], v[80:83], v[112:115]
    s_mov_b64 exec, s[72:73]
    s_nop 0
    v_and_or_b32 v84, v84, s5, v24
    v_and_or_b32 v85, v85, s5, v25
    v_and_or_b32 v86, v86, s5, v26
    v_and_or_b32 v87, v87, s5, v27
    buffer_store_dwordx4 v[84:87], v14, s[52:55], 0 offen offset:0 sc1
    v_and_or_b32 v88, v88, s5, v24
    v_and_or_b32 v89, v89, s5, v25
    v_and_or_b32 v90, v90, s5, v26
    v_and_or_b32 v91, v91, s5, v27
    buffer_store_dwordx4 v[88:91], v14, s[52:55], 0 offen offset:64 sc1
    v_and_or_b32 v92, v92, s5, v24
    v_and_or_b32 v93, v93, s5, v25
    v_and_or_b32 v94, v94, s5, v26
    v_and_or_b32 v95, v95, s5, v27
    buffer_store_dwordx4 v[92:95], v14, s[52:55], 0 offen offset:128 sc1
    v_and_or_b32 v96, v96, s5, v24
    v_and_or_b32 v97, v97, s5, v25
    v_and_or_b32 v98, v98, s5, v26
    v_and_or_b32 v99, v99, s5, v27
    buffer_store_dwordx4 v[96:99], v14, s[52:55], 0 offen offset:192 sc1
    v_and_or_b32 v100, v100, s5, v24
    v_and_or_b32 v101, v101, s5, v25
    v_and_or_b32 v102, v102, s5, v26
    v_and_or_b32 v103, v103, s5, v27
    buffer_store_dwordx4 v[100:103], v14, s[52:55], 0 offen offset:256 sc1
    v_and_or_b32 v104, v104, s5, v24
    v_and_or_b32 v105, v105, s5, v25
    v_and_or_b32 v106, v106, s5, v26
    v_and_or_b32 v107, v107, s5, v27
    buffer_store_dwordx4 v[104:107], v14, s[52:55], 0 offen offset:320 sc1
    v_and_or_b32 v108, v108, s5, v24
    v_and_or_b32 v109, v109, s5, v25
    v_and_or_b32 v110, v110, s5, v26
    v_and_or_b32 v111, v111, s5, v27
    buffer_store_dwordx4 v[108:111], v14, s[52:55], 0 offen offset:384 sc1
    v_and_or_b32 v112, v112, s5, v24
    v_and_or_b32 v113, v113, s5, v25
    v_and_or_b32 v114, v114, s5, v26
    v_and_or_b32 v115, v115, s5, v27
    buffer_store_dwordx4 v[112:115], v14, s[52:55], 0 offen offset:448 sc1
    s_mov_b64 exec, -1
    s_mov_b32 s70, 200000
L_fpoll:
    buffer_load_dwordx4 v[32:35], v3, s[52:55], s74 offen sc1
    buffer_load_dwordx4 v[36:39], v3, s[52:55], s75 offen sc1
    buffer_load_dwordx4 v[40:43], v3, s[52:55], s76 offen sc1
    buffer_load_dwordx4 v[44:47], v3, s[52:55], s77 offen sc1
    s_waitcnt vmcnt(3)
    v_xor_b32 v5, s16, v32
    v_bitop3_b32 v5, v5, v33, s17 bitop3:0xf6
    v_bitop3_b32 v5, v5, v34, s18 bitop3:0xf6
    v_bitop3_b32 v5, v5, v35, s19 bitop3:0xf6
    s_waitcnt vmcnt(2)
    v_bitop3_b32 v5, v5, v36, s16 bitop3:0xf6
    v_bitop3_b32 v5, v5, v37, s17 bitop3:0xf6
    v_bitop3_b32 v5, v5, v38, s18 bitop3:0xf6
    v_bitop3_b32 v5, v5, v39, s19 bitop3:0xf6
    s_waitcnt vmcnt(1)
    v_bitop3_b32 v5, v5, v40, s16 bitop3:0xf6
    v_bitop3_b32 v5, v5, v41, s17 bitop3:0xf6
    v_bitop3_b32 v5, v5, v42, s18 bitop3:0xf6
    v_bitop3_b32 v5, v5, v43, s19 bitop3:0xf6
    s_waitcnt vmcnt(0)
    v_bitop3_b32 v5, v5, v44, s16 bitop3:0xf6
    v_bitop3_b32 v5, v5, v45, s17 bitop3:0xf6
    v_bitop3_b32 v5, v5, v46, s18 bitop3:0xf6
    v_bitop3_b32 v5, v5, v47, s19 bitop3:0xf6
    v_and_b32 v5, 0xff, v5
    v_cmp_ne_u32 vcc, 0, v5
    s_cbranch_vccz L_fpoll_done
    s_mov_b64 exec, vcc
    s_sub_u32 s70, s70, 1
    s_cmp_lg_u32 s70, 0
    s_cbranch_scc1 L_fpoll
L_fpoll_done:
    s_mov_b64 exec, -1
    v_and_b32 v32, s5, v32
    v_and_b32 v33, s5, v33
    v_and_b32 v34, s5, v34
    v_and_b32 v35, s5, v35
    v_and_b32 v36, s5, v36
    v_and_b32 v37, s5, v37
    v_and_b32 v38, s5, v38
    v_and_b32 v39, s5, v39
    v_and_b32 v40, s5, v40
    v_and_b32 v41, s5, v41
    v_and_b32 v42, s5, v42
    v_and_b32 v43, s5, v43
    v_and_b32 v44, s5, v44
    v_and_b32 v45, s5, v45
    v_and_b32 v46, s5, v46
    v_and_b32 v47, s5, v47
    v_pk_add_f32 v[32:33], v[32:33], v[36:37]
    v_pk_add_f32 v[40:41], v[40:41], v[44:45]
    v_pk_add_f32 v[34:35], v[34:35], v[38:39]
    v_pk_add_f32 v[42:43], v[42:43], v[46:47]
    v_pk_add_f32 v[32:33], v[32:33], v[40:41]
    v_pk_add_f32 v[34:35], v[34:35], v[42:43]
    s_nop 1
    v_permlane32_swap_b32 v32, v33
    v_permlane32_swap_b32 v34, v35
    s_nop 1
    v_add_f32 v32, v32, v33
    v_add_f32 v34, v34, v35
    s_nop 1
    v_permlane16_swap_b32 v32, v34
    s_nop 1
    v_add_f32 v32, v32, v34
    s_nop 1
    v_add_f32_dpp v32, v32, v32 row_ror:4 row_mask:0xf bank_mask:0xf
    s_nop 1
    v_add_f32_dpp v32, v32, v32 row_ror:8 row_mask:0xf bank_mask:0xf
    s_mov_b32 s72, 0x000f000f
    s_mov_b32 s73, 0x000f000f
    v_cvt_pk_bf16_f32 v36, v32, v32
    s_mov_b64 exec, s[72:73]
    buffer_store_short v36, v4, s[60:63], 0 offen
    s_cmp_lg_u32 s2, 0
    s_cbranch_scc1 L_nononce
    s_mov_b64 exec, 1
    v_mov_b32 v5, 0
    buffer_store_dword v24, v5, s[52:55], 0 offen sc1
L_nononce:
    s_waitcnt vmcnt(0)
L_end:
    s_endpgm
.section .rodata,"a"
.p2align 6
.amdhsa_kernel gated_mix__sliding_block_cached__sliding_block_cached__decode_kernel
  .amdhsa_next_free_vgpr 256
  .amdhsa_next_free_sgpr 102
  .amdhsa_accum_offset 256
  .amdhsa_group_segment_fixed_size 0
  .amdhsa_kernarg_size 112
  .amdhsa_user_sgpr_count 2
  .amdhsa_user_sgpr_kernarg_segment_ptr 1
  .amdhsa_system_sgpr_workgroup_id_x 1
.end_amdhsa_kernel
```
